```python
import torch

def _softmax(x, axis=-1):
    return torch.softmax(x, dim=axis)
def _gelu(x):
    return torch.nn.functional.gelu(x, approximate="tanh")
def _silu(x):
    return torch.nn.functional.silu(x)
def _sigmoid(x):
    return torch.sigmoid(x)
def _layernorm(x, axis=-1, eps=1e-5):
    m = x.mean(dim=axis, keepdim=True)
    v = x.var(dim=axis, keepdim=True, unbiased=False)
    return (x - m) / torch.sqrt(v + eps)
def _scatter_add(tgt, idx, src, axis=0):
    return tgt.clone().index_add_(axis, idx, src)
def _segment_sum(src, seg, n):
    out = torch.zeros((n,) + src.shape[1:], dtype=src.dtype)
    return out.index_add_(0, seg, src)
def _pad(x, pw):
    flat = tuple(v for pair in reversed(pw) for v in pair)
    return torch.nn.functional.pad(x, flat)

kernel_name = 'sequential_preLN__linear_attn_block__dense_activation_mish__prompt'

def setup_inputs():

    _w = (lambda a: (lambda t: t.to(torch.bfloat16) if t.is_floating_point() else t)(torch.as_tensor(a)))
    def _A_setup():
        B, S, D = 1, 2048, 512
        return {
            "x": _w((lambda *s: torch.randn(*s, dtype=torch.bfloat16) * 0.05)(B, S, D)),
            "wqkv": _w((lambda *s: torch.randn(*s, dtype=torch.bfloat16) * 0.05)(D, 3 * D)),
            "wo": _w((lambda *s: torch.randn(*s, dtype=torch.bfloat16) * 0.05)(D, D)),
        }
    _A_in = _A_setup()

    def _B_setup():
        B, S, D, F = 1, 2048, 512, 1376
        return {
            "x": _w((lambda *s: torch.randn(*s, dtype=torch.bfloat16) * 0.05)(B, S, D)),
            "w1": _w((lambda *s: torch.randn(*s, dtype=torch.bfloat16) * 0.8)(D, F) * (D ** -0.5)),
            "b1": _w((lambda *s: torch.randn(*s, dtype=torch.bfloat16) * 0.2)(F)),
            "w2": _w((lambda *s: torch.randn(*s, dtype=torch.bfloat16) * 0.1)(F, D) * (F ** -0.5)),
        }
    _B_in = _B_setup()

    return {
        "A_x": _A_in["x"],
        "A_wqkv": _A_in["wqkv"],
        "A_wo": _A_in["wo"],
        "B_x": _B_in["x"],
        "B_w1": _B_in["w1"],
        "B_b1": _B_in["b1"],
        "B_w2": _B_in["w2"],
    }

def reference(A_x, A_wqkv, A_wo, B_x, B_w1, B_b1, B_w2):
    def _A_ref(x, wqkv, wo):
        B, S, D = x.shape
        H = 32; Dh = D // H
        qkv = (lambda x, *d: x.permute(*d))((x @ wqkv).reshape(B, S, 3, H, Dh), 2, 0, 3, 1, 4)
        q, k, v = qkv[0], qkv[1], qkv[2]
        phi = lambda t: torch.where(t > 0, t + 1, torch.exp(t)) + 1e-6
        pq, pk = phi(q), phi(k)
        kv = torch.einsum("bhsd,bhse->bhde", pk, v)
        z = torch.einsum("bhsd->bhd", pk)
        num = torch.einsum("bhqd,bhde->bhqe", pq, kv)
        den = torch.einsum("bhqd,bhd->bhq", pq, z)[..., None] + 1e-6
        o = num / den
        return (lambda x, *d: x.permute(*d))(o, 0, 2, 1, 3).reshape(B, S, D) @ wo

    def _B_ref(x, w1, b1, w2):
        h = torch.einsum("bsd,df->bsf", x, w1) + b1
        sp = torch.log1p(torch.exp(-torch.abs(h))) + torch.where(h > 0, h, torch.zeros_like(h))
        act = h * torch.tanh(sp)
        return torch.einsum("bsf,fd->bsd", act, w2)

    x = A_x
    h = x + _A_ref(_layernorm(x, axis=-1), A_wqkv, A_wo)
    h2 = h + _B_ref(_layernorm(h, axis=-1), B_w1, B_b1, B_w2)
    return h2
```

```asm
; @launch grid=(256,1,1) block=(512,1,1) lds=163840
.amdgcn_target "amdgcn-amd-amdhsa--gfx950"
.text
.globl sequential_preLN__linear_attn_block__dense_activation_mish__prompt_kernel
.p2align 8
.type sequential_preLN__linear_attn_block__dense_activation_mish__prompt_kernel,@function
sequential_preLN__linear_attn_block__dense_activation_mish__prompt_kernel:
    s_cmp_ge_u32 s2, 256
    s_cbranch_scc1 L_end
    s_load_dwordx4 s[64:67], s[0:1], 0
    s_load_dwordx2 s[68:69], s[0:1], 16
    s_load_dwordx4 s[72:75], s[0:1], 32
    s_load_dwordx4 s[76:79], s[0:1], 48
    s_load_dwordx4 s[80:83], s[0:1], 64
    s_and_b32 s3, s2, 7
    s_lshl_b32 s3, s3, 1
    s_lshr_b32 s4, s2, 7
    s_add_u32 s44, s3, s4
    s_lshr_b32 s45, s2, 3
    s_and_b32 s45, s45, 15
    v_lshrrev_b32 v19, 6, v0
    v_and_b32 v80, 63, v0
    v_readfirstlane_b32 s46, v19
    s_mov_b32 s60, 0x05040100
    s_mov_b32 s61, 0x07060302
    s_mov_b32 s62, 0x3f803f80
    v_mov_b32 v7, 0
    v_lshlrev_b32 v1, 4, v80
    v_and_b32 v81, 15, v80
    v_lshrrev_b32 v82, 4, v80
    v_and_b32 v83, 3, v80
    v_bfe_u32 v84, v80, 2, 2
    v_lshrrev_b32 v87, 3, v81
    v_and_b32 v86, 1, v82
    v_lshl_or_b32 v87, v86, 1, v87
    v_xor_b32 v87, v87, v81
    v_lshl_add_u32 v87, v82, 4, v87
    v_lshlrev_b32 v2, 4, v87
    v_add_u32 v6, 0x10000, v2
    v_xor_b32 v5, 64, v2
    v_add_u32 v0, 0x10000, v5
    v_add_u32 v3, 0x10000, v1
    v_add_u32 v4, 0x20000, v1
    s_xor_b32 s92, s46, 4
    s_and_b32 s55, s46, 3
    s_lshr_b32 s54, s46, 2
    s_lshl_b32 s53, s44, 3
    s_lshr_b32 s47, s45, 3
    s_lshl_b32 s5, s47, 2
    s_add_u32 s53, s53, s5
    s_add_u32 s53, s53, s55
    s_xor_b32 s5, s5, s46
    s_and_b32 s7, s45, 7
    s_lshl_b32 s4, s7, 1
    s_lshl_b32 s52, s7, 7
    s_mul_i32 s47, s45, 3
    s_and_b32 s48, s45, 1
    s_add_u32 s56, s47, s48
    s_xor_b32 s48, s48, 1
    s_lshl_b32 s48, s48, 1
    s_add_u32 s6, s47, s48
    s_lshl_b32 s47, s45, 1
    s_add_u32 s47, s47, 10
    s_cmp_lt_u32 s45, 10
    s_cselect_b32 s56, s56, s47
    s_cselect_b32 s6, s6, s47
    s_cmp_eq_u32 s45, 15
    s_cselect_b32 s6, 42, s6
    v_sub_u32 v86, 0, v82
    v_and_b32 v86, 3, v86
    v_xor_b32 v86, v86, v83
    v_lshrrev_b32 v16, 2, v80
    v_lshlrev_b32 v16, 10, v16
    v_lshl_add_u32 v16, v86, 4, v16
    s_lshl_b32 s63, s44, 3
    s_add_u32 s63, s63, s5
    s_lshl_b32 s63, s63, 14
    s_lshl_b32 s3, s46, 14
    s_add_u32 s3, s3, 24576
    v_lshrrev_b32 v86, 2, v81
    v_sub_u32 v86, 0, v86
    v_and_b32 v86, 3, v86
    v_xor_b32 v86, v86, v82
    v_lshlrev_b32 v86, 4, v86
    v_lshl_add_u32 v86, v81, 6, v86
    v_add_u32 v85, s3, v86
    v_lshrrev_b32 v8, 1, v82
    v_and_b32 v9, 1, v82
    v_lshlrev_b32 v10, 2, v84
    v_lshl_add_u32 v10, v8, 4, v10
    v_lshrrev_b32 v11, 1, v84
    v_lshl_add_u32 v11, v8, 1, v11
    v_and_b32 v12, 1, v84
    v_mov_b32 v86, 162816
    ds_write_b32 v86, v7
    ds_write_b32 v86, v7 offset:4
    ds_write_b32 v86, v7 offset:8
    ds_write_b32 v86, v7 offset:12
    s_waitcnt lgkmcnt(0)
    s_mov_b32 s12, s66
    s_and_b32 s13, s67, 0xffff
    s_mov_b32 s14, 1572864
    s_mov_b32 s15, 0x00020000
    s_mov_b32 s40, s82
    s_and_b32 s41, s83, 0xffff
    s_mov_b32 s42, 268435456
    s_mov_b32 s43, 0x00020000
    s_mov_b32 s8, s64
    s_and_b32 s9, s65, 0xffff
    s_mov_b32 s10, 2097152
    s_mov_b32 s11, 0x00020000
    s_mov_b32 s16, s68
    s_and_b32 s17, s69, 0xffff
    s_mov_b32 s18, 524288
    s_mov_b32 s19, 0x00020000
    s_mov_b32 s20, s72
    s_and_b32 s21, s73, 0xffff
    s_mov_b32 s22, 1409024
    s_mov_b32 s23, 0x00020000
    s_mov_b32 s24, s74
    s_and_b32 s25, s75, 0xffff
    s_mov_b32 s26, 2752
    s_mov_b32 s27, 0x00020000
    s_mov_b32 s28, s76
    s_and_b32 s29, s77, 0xffff
    s_mov_b32 s30, 1409024
    s_mov_b32 s31, 0x00020000
    s_mov_b32 s32, s78
    s_and_b32 s33, s79, 0xffff
    s_mov_b32 s34, 2097152
    s_mov_b32 s35, 0x00020000
    s_mov_b32 s36, s80
    s_and_b32 s37, s81, 0xffff
    s_mov_b32 s38, 256
    s_mov_b32 s39, 0x00020000
    s_cmp_lt_u32 s92, 4
    s_cbranch_scc1 L_rx
    s_cmp_eq_u32 s92, 7
    s_cbranch_scc1 L_r7
    s_cmp_eq_u32 s92, 6
    s_cbranch_scc1 L_rx
    s_and_b32 s47, s45, 1
    s_sub_u32 s48, s92, 4
    s_cmp_eq_u32 s47, 1
    s_cselect_b32 s49, 2, s48
    s_add_u32 s47, s49, 1
    s_cmp_eq_u32 s49, 2
    s_cselect_b32 s47, 0, s47
    s_lshl_b32 s47, s47, 10
    s_lshr_b32 s48, s45, 1
    s_lshl_b32 s48, s48, 7
    s_add_u32 s47, s47, s48
    s_mul_i32 s50, s44, 98304
    s_add_u32 s50, s50, s47
    s_mov_b32 s47, 3072
    v_mul_lo_u32 v86, v10, s47
    v_lshl_add_u32 v86, v9, 6, v86
    v_lshl_add_u32 v86, v83, 4, v86
    buffer_load_dwordx4 v[192:195], v86, s[12:15], s50 offen
    s_add_u32 s50, s50, 3072
    buffer_load_dwordx4 v[196:199], v86, s[12:15], s50 offen
    s_add_u32 s50, s50, 3072
    buffer_load_dwordx4 v[200:203], v86, s[12:15], s50 offen
    s_add_u32 s50, s50, 3072
    buffer_load_dwordx4 v[204:207], v86, s[12:15], s50 offen
    s_branch L_rx
L_r7:
    s_cmp_lg_u32 s2, 0
    s_cbranch_scc1 L_rx
    s_memrealtime s[48:49]
    s_waitcnt lgkmcnt(0)
    s_or_b32 s48, s48, 1
    v_mov_b32 v92, s48
    s_mov_b64 s[90:91], exec
    s_mov_b64 exec, 1
    buffer_store_dword v92, v7, s[36:39], 0 offen sc1
    s_mov_b64 exec, s[90:91]
    s_branch L_rx
L_rx:
    s_add_u32 m0, s3, 0
    s_add_u32 s51, s4, 0
    s_and_b32 s51, s51, 15
    s_lshl_b32 s51, s51, 6
    s_add_u32 s51, s51, s63
    buffer_load_dwordx4 v16, s[8:11], s51 offen lds
    s_add_u32 m0, s3, 1024
    s_add_u32 s51, s4, 1
    s_and_b32 s51, s51, 15
    s_lshl_b32 s51, s51, 6
    s_add_u32 s51, s51, s63
    buffer_load_dwordx4 v16, s[8:11], s51 offen lds
    s_add_u32 m0, s3, 2048
    s_add_u32 s51, s4, 2
    s_and_b32 s51, s51, 15
    s_lshl_b32 s51, s51, 6
    s_add_u32 s51, s51, s63
    buffer_load_dwordx4 v16, s[8:11], s51 offen lds
    s_add_u32 m0, s3, 3072
    s_add_u32 s51, s4, 3
    s_and_b32 s51, s51, 15
    s_lshl_b32 s51, s51, 6
    s_add_u32 s51, s51, s63
    buffer_load_dwordx4 v16, s[8:11], s51 offen lds
    s_cmp_lt_u32 s92, 4
    s_cbranch_scc1 L_apoll
    s_cmp_ge_u32 s92, 6
    s_cbranch_scc1 L_apoll
    s_and_b32 s47, s45, 1
    s_sub_u32 s48, s92, 4
    s_add_u32 s49, s47, s48
    s_cmp_eq_u32 s49, 2
    s_cbranch_scc1 L_a45x
    s_cmp_eq_u32 s47, 1
    s_cselect_b32 s49, 2, s48
    s_lshl_b32 s49, s49, 16
    s_lshr_b32 s48, s45, 1
    s_mul_i32 s48, s48, 196608
    s_add_u32 s49, s49, s48
    s_lshl_b32 s48, s44, 10
    s_add_u32 s49, s49, s48
    s_add_u32 s49, s49, 18874368
    s_mov_b32 s51, 16384
    s_waitcnt vmcnt(4)
    s_lshl_b32 s47, s92, 12
    s_add_u32 s47, s47, 0
    v_lshlrev_b32 v86, 8, v11
    v_lshl_add_u32 v86, v12, 3, v86
    v_add_u32 v86, s47, v86
    v_add_u32 v87, s47, v1
    v_lshl_add_u32 v86, v9, 11, v86
    v_lshrrev_b32 v88, 1, v83
    v_lshl_add_u32 v86, v88, 10, v86
    v_and_b32 v88, 1, v83
    v_lshl_add_u32 v86, v88, 7, v86
    v_perm_b32 v24, v196, v192, s60
    v_perm_b32 v26, v196, v192, s61
    v_perm_b32 v25, v204, v200, s60
    v_perm_b32 v27, v204, v200, s61
    v_perm_b32 v28, v197, v193, s60
    v_perm_b32 v30, v197, v193, s61
    v_perm_b32 v29, v205, v201, s60
    v_perm_b32 v31, v205, v201, s61
    v_perm_b32 v32, v198, v194, s60
    v_perm_b32 v34, v198, v194, s61
    v_perm_b32 v33, v206, v202, s60
    v_perm_b32 v35, v206, v202, s61
    v_perm_b32 v36, v199, v195, s60
    v_perm_b32 v38, v199, v195, s61
    v_perm_b32 v37, v207, v203, s60
    v_perm_b32 v39, v207, v203, s61
    ds_write_b64 v86, v[24:25] offset:0
    ds_write_b64 v86, v[26:27] offset:16
    ds_write_b64 v86, v[28:29] offset:32
    ds_write_b64 v86, v[30:31] offset:48
    ds_write_b64 v86, v[32:33] offset:64
    ds_write_b64 v86, v[34:35] offset:80
    ds_write_b64 v86, v[36:37] offset:96
    ds_write_b64 v86, v[38:39] offset:112
    s_waitcnt lgkmcnt(0)
    ds_read_b128 v[40:43], v87 offset:0
    ds_read_b128 v[44:47], v87 offset:1024
    ds_read_b128 v[48:51], v87 offset:2048
    ds_read_b128 v[52:55], v87 offset:3072
    s_waitcnt lgkmcnt(0)
    buffer_store_dwordx4 v[40:43], v1, s[40:43], s49 offen sc1
    s_add_u32 s49, s49, s51
    buffer_store_dwordx4 v[44:47], v1, s[40:43], s49 offen sc1
    s_add_u32 s49, s49, s51
    buffer_store_dwordx4 v[48:51], v1, s[40:43], s49 offen sc1
    s_add_u32 s49, s49, s51
    buffer_store_dwordx4 v[52:55], v1, s[40:43], s49 offen sc1
L_asf_1:
    s_mov_b32 s57, 0
L_ep_2:
    buffer_load_dword v88, v7, s[36:39], 0 offen sc1
    s_add_u32 s57, s57, 1
    s_waitcnt vmcnt(0)
    v_readfirstlane_b32 s59, v88
    s_cmp_gt_u32 s57, 200000
    s_cbranch_scc1 L_epx_3
    s_cmp_eq_u32 s59, 0
    s_cbranch_scc1 L_ep_2
L_epx_3:
    s_lshl_b32 s47, s45, 4
    s_add_u32 s47, s47, s44
    s_add_u32 s47, s47, 1024
    s_lshl_b32 s47, s47, 7
    s_lshl_b32 s48, s92, 3
    s_add_u32 s47, s47, s48
    v_mov_b32 v14, s59
    v_not_b32 v15, s59
    s_mov_b64 s[90:91], exec
    s_mov_b64 exec, 1
    s_waitcnt vmcnt(0)
    buffer_store_dwordx2 v[14:15], v7, s[40:43], s47 offen sc1
    s_mov_b64 exec, s[90:91]
L_a45x:
L_apoll:
L_b0:
    s_barrier
    s_add_u32 m0, s3, 4096
    s_add_u32 s51, s4, 4
    s_and_b32 s51, s51, 15
    s_lshl_b32 s51, s51, 6
    s_add_u32 s51, s51, s63
    buffer_load_dwordx4 v16, s[8:11], s51 offen lds
    s_add_u32 m0, s3, 5120
    s_add_u32 s51, s4, 5
    s_and_b32 s51, s51, 15
    s_lshl_b32 s51, s51, 6
    s_add_u32 s51, s51, s63
    buffer_load_dwordx4 v16, s[8:11], s51 offen lds
    s_add_u32 m0, s3, 6144
    s_add_u32 s51, s4, 6
    s_and_b32 s51, s51, 15
    s_lshl_b32 s51, s51, 6
    s_add_u32 s51, s51, s63
    buffer_load_dwordx4 v16, s[8:11], s51 offen lds
    s_add_u32 m0, s3, 7168
    s_add_u32 s51, s4, 7
    s_and_b32 s51, s51, 15
    s_lshl_b32 s51, s51, 6
    s_add_u32 s51, s51, s63
    buffer_load_dwordx4 v16, s[8:11], s51 offen lds
    s_add_u32 m0, s3, 8192
    s_add_u32 s51, s4, 8
    s_and_b32 s51, s51, 15
    s_lshl_b32 s51, s51, 6
    s_add_u32 s51, s51, s63
    buffer_load_dwordx4 v16, s[8:11], s51 offen lds
    s_add_u32 m0, s3, 9216
    s_add_u32 s51, s4, 9
    s_and_b32 s51, s51, 15
    s_lshl_b32 s51, s51, 6
    s_add_u32 s51, s51, s63
    buffer_load_dwordx4 v16, s[8:11], s51 offen lds
    s_add_u32 m0, s3, 10240
    s_add_u32 s51, s4, 10
    s_and_b32 s51, s51, 15
    s_lshl_b32 s51, s51, 6
    s_add_u32 s51, s51, s63
    buffer_load_dwordx4 v16, s[8:11], s51 offen lds
    s_add_u32 m0, s3, 11264
    s_add_u32 s51, s4, 11
    s_and_b32 s51, s51, 15
    s_lshl_b32 s51, s51, 6
    s_add_u32 s51, s51, s63
    buffer_load_dwordx4 v16, s[8:11], s51 offen lds
    s_add_u32 m0, s3, 12288
    s_add_u32 s51, s4, 12
    s_and_b32 s51, s51, 15
    s_lshl_b32 s51, s51, 6
    s_add_u32 s51, s51, s63
    buffer_load_dwordx4 v16, s[8:11], s51 offen lds
    s_add_u32 m0, s3, 13312
    s_add_u32 s51, s4, 13
    s_and_b32 s51, s51, 15
    s_lshl_b32 s51, s51, 6
    s_add_u32 s51, s51, s63
    buffer_load_dwordx4 v16, s[8:11], s51 offen lds
    s_add_u32 m0, s3, 14336
    s_add_u32 s51, s4, 14
    s_and_b32 s51, s51, 15
    s_lshl_b32 s51, s51, 6
    s_add_u32 s51, s51, s63
    buffer_load_dwordx4 v16, s[8:11], s51 offen lds
    s_add_u32 m0, s3, 15360
    s_add_u32 s51, s4, 15
    s_and_b32 s51, s51, 15
    s_lshl_b32 s51, s51, 6
    s_add_u32 s51, s51, s63
    buffer_load_dwordx4 v16, s[8:11], s51 offen lds
    s_waitcnt vmcnt(0)
    ds_read_b128 v[104:107], v85 offset:0
    ds_read_b128 v[108:111], v85 offset:1024
    ds_read_b128 v[112:115], v85 offset:2048
    ds_read_b128 v[116:119], v85 offset:3072
    ds_read_b128 v[120:123], v85 offset:4096
    ds_read_b128 v[124:127], v85 offset:5120
    ds_read_b128 v[128:131], v85 offset:6144
    ds_read_b128 v[132:135], v85 offset:7168
    ds_read_b128 v[136:139], v85 offset:8192
    ds_read_b128 v[140:143], v85 offset:9216
    ds_read_b128 v[144:147], v85 offset:10240
    ds_read_b128 v[148:151], v85 offset:11264
    ds_read_b128 v[152:155], v85 offset:12288
    ds_read_b128 v[156:159], v85 offset:13312
    ds_read_b128 v[160:163], v85 offset:14336
    ds_read_b128 v[164:167], v85 offset:15360
    s_waitcnt lgkmcnt(0)
    s_lshl_b32 s3, s46, 12
    s_add_u32 s3, s3, 98304
    v_mov_b32 v17, 0
    v_mov_b32 v18, 0
    v_mov_b32 v88, 0
    v_mov_b32 v89, 0
    v_dot2c_f32_bf16 v17, s62, v104
    v_dot2c_f32_bf16 v18, v104, v104
    v_dot2c_f32_bf16 v88, s62, v105
    v_dot2c_f32_bf16 v89, v105, v105
    v_dot2c_f32_bf16 v17, s62, v106
    v_dot2c_f32_bf16 v18, v106, v106
    v_dot2c_f32_bf16 v88, s62, v107
    v_dot2c_f32_bf16 v89, v107, v107
    v_dot2c_f32_bf16 v17, s62, v108
    v_dot2c_f32_bf16 v18, v108, v108
    v_dot2c_f32_bf16 v88, s62, v109
    v_dot2c_f32_bf16 v89, v109, v109
    v_dot2c_f32_bf16 v17, s62, v110
    v_dot2c_f32_bf16 v18, v110, v110
    v_dot2c_f32_bf16 v88, s62, v111
    v_dot2c_f32_bf16 v89, v111, v111
    v_dot2c_f32_bf16 v17, s62, v112
    v_dot2c_f32_bf16 v18, v112, v112
    v_dot2c_f32_bf16 v88, s62, v113
    v_dot2c_f32_bf16 v89, v113, v113
    v_dot2c_f32_bf16 v17, s62, v114
    v_dot2c_f32_bf16 v18, v114, v114
    v_dot2c_f32_bf16 v88, s62, v115
    v_dot2c_f32_bf16 v89, v115, v115
    v_dot2c_f32_bf16 v17, s62, v116
    v_dot2c_f32_bf16 v18, v116, v116
    v_dot2c_f32_bf16 v88, s62, v117
    v_dot2c_f32_bf16 v89, v117, v117
    v_dot2c_f32_bf16 v17, s62, v118
    v_dot2c_f32_bf16 v18, v118, v118
    v_dot2c_f32_bf16 v88, s62, v119
    v_dot2c_f32_bf16 v89, v119, v119
    v_dot2c_f32_bf16 v17, s62, v120
    v_dot2c_f32_bf16 v18, v120, v120
    v_dot2c_f32_bf16 v88, s62, v121
    v_dot2c_f32_bf16 v89, v121, v121
    v_dot2c_f32_bf16 v17, s62, v122
    v_dot2c_f32_bf16 v18, v122, v122
    v_dot2c_f32_bf16 v88, s62, v123
    v_dot2c_f32_bf16 v89, v123, v123
    v_dot2c_f32_bf16 v17, s62, v124
    v_dot2c_f32_bf16 v18, v124, v124
    v_dot2c_f32_bf16 v88, s62, v125
    v_dot2c_f32_bf16 v89, v125, v125
    v_dot2c_f32_bf16 v17, s62, v126
    v_dot2c_f32_bf16 v18, v126, v126
    v_dot2c_f32_bf16 v88, s62, v127
    v_dot2c_f32_bf16 v89, v127, v127
    v_dot2c_f32_bf16 v17, s62, v128
    v_dot2c_f32_bf16 v18, v128, v128
    v_dot2c_f32_bf16 v88, s62, v129
    v_dot2c_f32_bf16 v89, v129, v129
    v_dot2c_f32_bf16 v17, s62, v130
    v_dot2c_f32_bf16 v18, v130, v130
    v_dot2c_f32_bf16 v88, s62, v131
    v_dot2c_f32_bf16 v89, v131, v131
    v_dot2c_f32_bf16 v17, s62, v132
    v_dot2c_f32_bf16 v18, v132, v132
    v_dot2c_f32_bf16 v88, s62, v133
    v_dot2c_f32_bf16 v89, v133, v133
    v_dot2c_f32_bf16 v17, s62, v134
    v_dot2c_f32_bf16 v18, v134, v134
    v_dot2c_f32_bf16 v88, s62, v135
    v_dot2c_f32_bf16 v89, v135, v135
    v_dot2c_f32_bf16 v17, s62, v136
    v_dot2c_f32_bf16 v18, v136, v136
    v_dot2c_f32_bf16 v88, s62, v137
    v_dot2c_f32_bf16 v89, v137, v137
    v_dot2c_f32_bf16 v17, s62, v138
    v_dot2c_f32_bf16 v18, v138, v138
    v_dot2c_f32_bf16 v88, s62, v139
    v_dot2c_f32_bf16 v89, v139, v139
    v_dot2c_f32_bf16 v17, s62, v140
    v_dot2c_f32_bf16 v18, v140, v140
    v_dot2c_f32_bf16 v88, s62, v141
    v_dot2c_f32_bf16 v89, v141, v141
    v_dot2c_f32_bf16 v17, s62, v142
    v_dot2c_f32_bf16 v18, v142, v142
    v_dot2c_f32_bf16 v88, s62, v143
    v_dot2c_f32_bf16 v89, v143, v143
    v_dot2c_f32_bf16 v17, s62, v144
    v_dot2c_f32_bf16 v18, v144, v144
    v_dot2c_f32_bf16 v88, s62, v145
    v_dot2c_f32_bf16 v89, v145, v145
    v_dot2c_f32_bf16 v17, s62, v146
    v_dot2c_f32_bf16 v18, v146, v146
    v_dot2c_f32_bf16 v88, s62, v147
    v_dot2c_f32_bf16 v89, v147, v147
    v_dot2c_f32_bf16 v17, s62, v148
    v_dot2c_f32_bf16 v18, v148, v148
    v_dot2c_f32_bf16 v88, s62, v149
    v_dot2c_f32_bf16 v89, v149, v149
    v_dot2c_f32_bf16 v17, s62, v150
    v_dot2c_f32_bf16 v18, v150, v150
    v_dot2c_f32_bf16 v88, s62, v151
    v_dot2c_f32_bf16 v89, v151, v151
    v_dot2c_f32_bf16 v17, s62, v152
    v_dot2c_f32_bf16 v18, v152, v152
    v_dot2c_f32_bf16 v88, s62, v153
    v_dot2c_f32_bf16 v89, v153, v153
    v_dot2c_f32_bf16 v17, s62, v154
    v_dot2c_f32_bf16 v18, v154, v154
    v_dot2c_f32_bf16 v88, s62, v155
    v_dot2c_f32_bf16 v89, v155, v155
    v_dot2c_f32_bf16 v17, s62, v156
    v_dot2c_f32_bf16 v18, v156, v156
    v_dot2c_f32_bf16 v88, s62, v157
    v_dot2c_f32_bf16 v89, v157, v157
    v_dot2c_f32_bf16 v17, s62, v158
    v_dot2c_f32_bf16 v18, v158, v158
    v_dot2c_f32_bf16 v88, s62, v159
    v_dot2c_f32_bf16 v89, v159, v159
    v_dot2c_f32_bf16 v17, s62, v160
    v_dot2c_f32_bf16 v18, v160, v160
    v_dot2c_f32_bf16 v88, s62, v161
    v_dot2c_f32_bf16 v89, v161, v161
    v_dot2c_f32_bf16 v17, s62, v162
    v_dot2c_f32_bf16 v18, v162, v162
    v_dot2c_f32_bf16 v88, s62, v163
    v_dot2c_f32_bf16 v89, v163, v163
    v_dot2c_f32_bf16 v17, s62, v164
    v_dot2c_f32_bf16 v18, v164, v164
    v_dot2c_f32_bf16 v88, s62, v165
    v_dot2c_f32_bf16 v89, v165, v165
    v_dot2c_f32_bf16 v17, s62, v166
    v_dot2c_f32_bf16 v18, v166, v166
    v_dot2c_f32_bf16 v88, s62, v167
    v_dot2c_f32_bf16 v89, v167, v167
    s_nop 1
    v_add_f32 v17, v17, v88
    v_add_f32 v18, v18, v89
    v_mov_b32 v86, v17
    v_mov_b32 v87, v18
    s_nop 0
    v_permlane32_swap_b32 v17, v86
    v_permlane32_swap_b32 v18, v87
    v_add_f32 v17, v17, v86
    v_add_f32 v18, v18, v87
    v_mov_b32 v86, v17
    v_mov_b32 v87, v18
    s_nop 0
    v_permlane16_swap_b32 v17, v86
    v_permlane16_swap_b32 v18, v87
    v_add_f32 v17, v17, v86
    v_add_f32 v18, v18, v87
    v_mul_f32 v17, 0x3b000000, v17
    v_mul_f32 v18, 0x3b000000, v18
    v_fma_f32 v18, -v17, v17, v18
    v_max_f32 v18, 0, v18
    v_add_f32 v18, 0x3727c5ac, v18
    v_rsq_f32 v18, v18
    s_nop 0
    v_mul_f32 v17, v17, v18
    v_lshlrev_b32 v86, 4, v82
    ds_bpermute_b32 v216, v86, v18 offset:0
    ds_bpermute_b32 v220, v86, v17 offset:0
    ds_bpermute_b32 v217, v86, v18 offset:4
    ds_bpermute_b32 v221, v86, v17 offset:4
    ds_bpermute_b32 v218, v86, v18 offset:8
    ds_bpermute_b32 v222, v86, v17 offset:8
    ds_bpermute_b32 v219, v86, v18 offset:12
    ds_bpermute_b32 v223, v86, v17 offset:12
    s_waitcnt lgkmcnt(0)
    s_cmp_lg_u32 s92, 6
    s_cbranch_scc1 L_b1
    s_mov_b32 s57, 0
L_ep_4:
    buffer_load_dword v88, v7, s[36:39], 0 offen sc1
    s_add_u32 s57, s57, 1
    s_waitcnt vmcnt(0)
    v_readfirstlane_b32 s59, v88
    s_cmp_gt_u32 s57, 200000
    s_cbranch_scc1 L_epx_5
    s_cmp_eq_u32 s59, 0
    s_cbranch_scc1 L_ep_4
L_epx_5:
    v_mov_b32 v86, 162944
    v_mov_b32 v87, s59
    ds_write_b32 v86, v87
    s_waitcnt lgkmcnt(0)
    s_cmp_lg_u32 s46, 2
    s_cbranch_scc1 L_pskip_6
    v_lshlrev_b32 v86, 7, v81
    v_add_u32 v86, 32, v86
    v_and_b32 v87, 1, v82
    v_lshl_add_u32 v86, v87, 11, v86
    s_and_b32 s47, s45, 14
    s_add_u32 s47, s47, 64
    s_lshl_b32 s47, s47, 11
    v_mov_b32 v92, -1
    v_subrev_u32 v93, 1, v87
    s_mov_b32 s57, 0
    s_not_b32 s48, s59
L_poll_7:
    buffer_load_dwordx4 v[88:91], v86, s[40:43], s47 offen sc1
    s_add_u32 s57, s57, 1
    s_waitcnt vmcnt(0)
    v_xor_b32 v88, s59, v88
    v_xor_b32 v89, s48, v89
    v_xor_b32 v90, s59, v90
    v_xor_b32 v91, s48, v91
    v_or_b32 v88, v88, v89
    v_or_b32 v90, v90, v91
    v_and_b32 v88, v88, v92
    v_and_b32 v90, v90, v93
    v_or_b32 v88, v88, v90
    v_cmp_eq_u32 vcc, 0, v88
    s_cmp_gt_u32 s57, 200000
    s_cbranch_scc1 L_pskip_6
    s_cmp_eq_u64 vcc, exec
    s_cbranch_scc0 L_poll_7
L_pskip_6:
L_b1:
    s_barrier
    v_mov_b32 v86, 162944
    ds_read_b32 v87, v86
    s_waitcnt lgkmcnt(0)
    v_readfirstlane_b32 s59, v87
    s_lshr_b32 s47, s46, 1
    s_lshl_b32 s47, s47, 14
    s_lshr_b32 s48, s45, 1
    s_mul_i32 s48, s48, 196608
    s_and_b32 s50, s45, 1
    s_lshl_b32 s50, s50, 15
    s_add_u32 s48, s48, s50
    s_add_u32 s48, s48, 18874368
    s_lshr_b32 s50, s46, 2
    s_lshl_b32 s50, s50, 16
    s_add_u32 s48, s48, s50
    s_lshr_b32 s50, s46, 1
    s_and_b32 s50, s50, 1
    s_lshl_b32 s50, s50, 14
    s_add_u32 s48, s48, s50
    s_and_b32 s49, s46, 1
    s_lshl_b32 s49, s49, 2
    s_add_u32 s49, s49, 0
    s_add_u32 s50, s49, 0
    s_lshl_b32 s51, s50, 10
    s_add_u32 m0, s51, s47
    s_add_u32 s50, s50, s4
    s_and_b32 s50, s50, 15
    s_lshl_b32 s50, s50, 10
    s_add_u32 s50, s50, s48
    buffer_load_dwordx4 v1, s[40:43], s50 offen offset:0 sc1 lds
    buffer_load_dwordx4 v1, s[40:43], s50 offen offset:1024 sc1 lds
    s_add_u32 s50, s49, 2
    s_lshl_b32 s51, s50, 10
    s_add_u32 m0, s51, s47
    s_add_u32 s50, s50, s4
    s_and_b32 s50, s50, 15
    s_lshl_b32 s50, s50, 10
    s_add_u32 s50, s50, s48
    buffer_load_dwordx4 v1, s[40:43], s50 offen offset:0 sc1 lds
    buffer_load_dwordx4 v1, s[40:43], s50 offen offset:1024 sc1 lds
    s_barrier
    s_lshr_b32 s47, s46, 1
    s_lshl_b32 s47, s47, 14
    s_lshr_b32 s48, s45, 1
    s_mul_i32 s48, s48, 196608
    s_and_b32 s50, s45, 1
    s_lshl_b32 s50, s50, 15
    s_add_u32 s48, s48, s50
    s_add_u32 s48, s48, 18874368
    s_lshr_b32 s50, s46, 2
    s_lshl_b32 s50, s50, 16
    s_add_u32 s48, s48, s50
    s_lshr_b32 s50, s46, 1
    s_and_b32 s50, s50, 1
    s_lshl_b32 s50, s50, 14
    s_add_u32 s48, s48, s50
    s_and_b32 s49, s46, 1
    s_lshl_b32 s49, s49, 2
    s_add_u32 s49, s49, 8
    s_add_u32 s50, s49, 0
    s_lshl_b32 s51, s50, 10
    s_add_u32 m0, s51, s47
    s_add_u32 s50, s50, s4
    s_and_b32 s50, s50, 15
    s_lshl_b32 s50, s50, 10
    s_add_u32 s50, s50, s48
    buffer_load_dwordx4 v1, s[40:43], s50 offen offset:0 sc1 lds
    buffer_load_dwordx4 v1, s[40:43], s50 offen offset:1024 sc1 lds
    s_add_u32 s50, s49, 2
    s_lshl_b32 s51, s50, 10
    s_add_u32 m0, s51, s47
    s_add_u32 s50, s50, s4
    s_and_b32 s50, s50, 15
    s_lshl_b32 s50, s50, 10
    s_add_u32 s50, s50, s48
    buffer_load_dwordx4 v1, s[40:43], s50 offen offset:0 sc1 lds
    buffer_load_dwordx4 v1, s[40:43], s50 offen offset:1024 sc1 lds
    s_barrier
    s_lshr_b32 s47, s46, 2
    s_lshl_b32 s47, s47, 14
    s_add_u32 s47, s47, 65536
    s_lshr_b32 s48, s45, 1
    s_mul_i32 s48, s48, 196608
    s_and_b32 s50, s45, 1
    s_lshl_b32 s50, s50, 15
    s_add_u32 s48, s48, s50
    s_add_u32 s48, s48, 18874368
    s_add_u32 s48, s48, 131072
    s_lshr_b32 s50, s46, 2
    s_lshl_b32 s50, s50, 14
    s_add_u32 s48, s48, s50
    s_and_b32 s49, s46, 3
    s_lshl_b32 s49, s49, 2
    s_add_u32 s50, s49, 0
    s_lshl_b32 s51, s50, 10
    s_add_u32 m0, s51, s47
    s_add_u32 s50, s50, s4
    s_and_b32 s50, s50, 15
    s_lshl_b32 s50, s50, 10
    s_add_u32 s50, s50, s48
    buffer_load_dwordx4 v1, s[40:43], s50 offen offset:0 sc1 lds
    buffer_load_dwordx4 v1, s[40:43], s50 offen offset:1024 sc1 lds
    s_add_u32 s50, s49, 2
    s_lshl_b32 s51, s50, 10
    s_add_u32 m0, s51, s47
    s_add_u32 s50, s50, s4
    s_and_b32 s50, s50, 15
    s_lshl_b32 s50, s50, 10
    s_add_u32 s50, s50, s48
    buffer_load_dwordx4 v1, s[40:43], s50 offen offset:0 sc1 lds
    buffer_load_dwordx4 v1, s[40:43], s50 offen offset:1024 sc1 lds
    s_waitcnt vmcnt(8)
    s_barrier
    s_cmp_ge_u32 s46, 4
    s_cbranch_scc1 L_n03
L_r03:
    s_cmp_ge_u32 s46, 2
    s_cbranch_scc1 L_r23
    s_mov_b32 s47, 2752
    v_mul_lo_u32 v86, v10, s47
    s_xor_b32 s47, s46, 1
    v_mul_lo_u32 v87, v9, s47
    v_lshl_add_u32 v86, v87, 6, v86
    v_lshl_add_u32 v86, v83, 4, v86
    s_cmp_eq_u32 s46, 0
    s_cselect_b32 s47, s56, s6
    s_lshl_b32 s47, s47, 6
    s_mul_i32 s50, s44, 88064
    s_add_u32 s50, s50, s47
    buffer_load_dwordx4 v[192:195], v86, s[20:23], s50 offen
    s_add_u32 s50, s50, 2752
    buffer_load_dwordx4 v[196:199], v86, s[20:23], s50 offen
    s_add_u32 s50, s50, 2752
    buffer_load_dwordx4 v[200:203], v86, s[20:23], s50 offen
    s_add_u32 s50, s50, 2752
    buffer_load_dwordx4 v[204:207], v86, s[20:23], s50 offen
    s_branch L_r03e
L_r23:
    s_lshr_b32 s47, s45, 3
    s_add_u32 s48, s47, s46
    s_cmp_eq_u32 s48, 2
    s_cbranch_scc0 L_rw2
    v_lshlrev_b32 v86, 2, v11
    v_lshl_add_u32 v86, v12, 4, v86
    v_lshlrev_b32 v86, 10, v86
    v_lshl_add_u32 v86, v9, 6, v86
    v_lshl_add_u32 v86, v83, 4, v86
    s_lshl_b32 s50, s44, 15
    s_add_u32 s50, s50, s52
    buffer_load_dwordx4 v[192:195], v86, s[16:19], s50 offen
    s_add_u32 s50, s50, 1024
    buffer_load_dwordx4 v[196:199], v86, s[16:19], s50 offen
    s_add_u32 s50, s50, 1024
    buffer_load_dwordx4 v[200:203], v86, s[16:19], s50 offen
    s_add_u32 s50, s50, 1024
    buffer_load_dwordx4 v[204:207], v86, s[16:19], s50 offen
    s_branch L_r03e
L_rw2:
    s_sub_u32 s48, s46, 1
    s_mul_i32 s48, s48, s47
    s_lshl_b32 s48, s48, 4
    s_add_u32 s48, s48, s44
    v_lshlrev_b32 v86, 10, v10
    v_lshl_add_u32 v86, v9, 6, v86
    v_lshl_add_u32 v86, v83, 4, v86
    s_lshl_b32 s50, s48, 15
    s_add_u32 s50, s50, s52
    buffer_load_dwordx4 v[192:195], v86, s[28:31], s50 offen
    s_add_u32 s50, s50, 1024
    buffer_load_dwordx4 v[196:199], v86, s[28:31], s50 offen
    s_add_u32 s50, s50, 1024
    buffer_load_dwordx4 v[200:203], v86, s[28:31], s50 offen
    s_add_u32 s50, s50, 1024
    buffer_load_dwordx4 v[204:207], v86, s[28:31], s50 offen
L_r03e:
L_n03:
    s_setprio 2
    ds_read_b128 v[24:27], v1 offset:0
    ds_read_b128 v[28:31], v1 offset:16384
    ds_read_b128 v[32:35], v1 offset:32768
    ds_read_b128 v[36:39], v1 offset:49152
    ds_read_b128 v[40:43], v1 offset:1024
    ds_read_b128 v[44:47], v1 offset:17408
    s_waitcnt lgkmcnt(5)
    v_mfma_f32_16x16x32_bf16 v[56:59], v[104:107], v[24:27], 0
    ds_read_b128 v[48:51], v1 offset:33792
    s_waitcnt lgkmcnt(5)
    v_mfma_f32_16x16x32_bf16 v[60:63], v[104:107], v[28:31], 0
    ds_read_b128 v[52:55], v1 offset:50176
    s_waitcnt lgkmcnt(5)
    v_mfma_f32_16x16x32_bf16 v[64:67], v[104:107], v[32:35], 0
    ds_read_b128 v[24:27], v1 offset:2048
    s_waitcnt lgkmcnt(5)
    v_mfma_f32_16x16x32_bf16 v[68:71], v[104:107], v[36:39], 0
    ds_read_b128 v[28:31], v1 offset:18432
    s_waitcnt lgkmcnt(5)
    v_mfma_f32_16x16x32_bf16 v[56:59], v[108:111], v[40:43], v[56:59]
    ds_read_b128 v[32:35], v1 offset:34816
    s_waitcnt lgkmcnt(5)
    v_mfma_f32_16x16x32_bf16 v[60:63], v[108:111], v[44:47], v[60:63]
    ds_read_b128 v[36:39], v1 offset:51200
    s_waitcnt lgkmcnt(5)
    v_mfma_f32_16x16x32_bf16 v[64:67], v[108:111], v[48:51], v[64:67]
    ds_read_b128 v[40:43], v1 offset:3072
    s_waitcnt lgkmcnt(5)
    v_mfma_f32_16x16x32_bf16 v[68:71], v[108:111], v[52:55], v[68:71]
    ds_read_b128 v[44:47], v1 offset:19456
    s_waitcnt lgkmcnt(5)
    v_mfma_f32_16x16x32_bf16 v[56:59], v[112:115], v[24:27], v[56:59]
    ds_read_b128 v[48:51], v1 offset:35840
    s_waitcnt lgkmcnt(5)
    v_mfma_f32_16x16x32_bf16 v[60:63], v[112:115], v[28:31], v[60:63]
    ds_read_b128 v[52:55], v1 offset:52224
    s_waitcnt lgkmcnt(5)
    v_mfma_f32_16x16x32_bf16 v[64:67], v[112:115], v[32:35], v[64:67]
    ds_read_b128 v[24:27], v1 offset:4096
    s_waitcnt lgkmcnt(5)
    v_mfma_f32_16x16x32_bf16 v[68:71], v[112:115], v[36:39], v[68:71]
    ds_read_b128 v[28:31], v1 offset:20480
    s_waitcnt lgkmcnt(5)
    v_mfma_f32_16x16x32_bf16 v[56:59], v[116:119], v[40:43], v[56:59]
    ds_read_b128 v[32:35], v1 offset:36864
    s_waitcnt lgkmcnt(5)
    v_mfma_f32_16x16x32_bf16 v[60:63], v[116:119], v[44:47], v[60:63]
    ds_read_b128 v[36:39], v1 offset:53248
    s_waitcnt lgkmcnt(5)
    v_mfma_f32_16x16x32_bf16 v[64:67], v[116:119], v[48:51], v[64:67]
    ds_read_b128 v[40:43], v1 offset:5120
    s_waitcnt lgkmcnt(5)
    v_mfma_f32_16x16x32_bf16 v[68:71], v[116:119], v[52:55], v[68:71]
    ds_read_b128 v[44:47], v1 offset:21504
    s_waitcnt lgkmcnt(5)
    v_mfma_f32_16x16x32_bf16 v[56:59], v[120:123], v[24:27], v[56:59]
    ds_read_b128 v[48:51], v1 offset:37888
    s_waitcnt lgkmcnt(5)
    v_mfma_f32_16x16x32_bf16 v[60:63], v[120:123], v[28:31], v[60:63]
    ds_read_b128 v[52:55], v1 offset:54272
    s_waitcnt lgkmcnt(5)
    v_mfma_f32_16x16x32_bf16 v[64:67], v[120:123], v[32:35], v[64:67]
    ds_read_b128 v[24:27], v1 offset:6144
    s_waitcnt lgkmcnt(5)
    v_mfma_f32_16x16x32_bf16 v[68:71], v[120:123], v[36:39], v[68:71]
    ds_read_b128 v[28:31], v1 offset:22528
    s_waitcnt lgkmcnt(5)
    v_mfma_f32_16x16x32_bf16 v[56:59], v[124:127], v[40:43], v[56:59]
    ds_read_b128 v[32:35], v1 offset:38912
    s_waitcnt lgkmcnt(5)
    v_mfma_f32_16x16x32_bf16 v[60:63], v[124:127], v[44:47], v[60:63]
    ds_read_b128 v[36:39], v1 offset:55296
    s_waitcnt lgkmcnt(5)
    v_mfma_f32_16x16x32_bf16 v[64:67], v[124:127], v[48:51], v[64:67]
    ds_read_b128 v[40:43], v1 offset:7168
    s_waitcnt lgkmcnt(5)
    v_mfma_f32_16x16x32_bf16 v[68:71], v[124:127], v[52:55], v[68:71]
    ds_read_b128 v[44:47], v1 offset:23552
    s_waitcnt lgkmcnt(5)
    v_mfma_f32_16x16x32_bf16 v[56:59], v[128:131], v[24:27], v[56:59]
    ds_read_b128 v[48:51], v1 offset:39936
    s_waitcnt lgkmcnt(5)
    v_mfma_f32_16x16x32_bf16 v[60:63], v[128:131], v[28:31], v[60:63]
    ds_read_b128 v[52:55], v1 offset:56320
    s_waitcnt lgkmcnt(5)
    v_mfma_f32_16x16x32_bf16 v[64:67], v[128:131], v[32:35], v[64:67]
    s_waitcnt lgkmcnt(4)
    v_mfma_f32_16x16x32_bf16 v[68:71], v[128:131], v[36:39], v[68:71]
    s_waitcnt lgkmcnt(3)
    v_mfma_f32_16x16x32_bf16 v[56:59], v[132:135], v[40:43], v[56:59]
    s_waitcnt lgkmcnt(2)
    v_mfma_f32_16x16x32_bf16 v[60:63], v[132:135], v[44:47], v[60:63]
    s_waitcnt lgkmcnt(1)
    v_mfma_f32_16x16x32_bf16 v[64:67], v[132:135], v[48:51], v[64:67]
    s_waitcnt lgkmcnt(0)
    v_mfma_f32_16x16x32_bf16 v[68:71], v[132:135], v[52:55], v[68:71]
    s_setprio 0
    s_waitcnt vmcnt(4)
    s_barrier
    s_cmp_ge_u32 s46, 4
    s_cbranch_scc1 L_nocs_8
    s_add_u32 s48, s46, 0
    s_lshl_b32 s47, s48, 14
    s_add_u32 s47, s47, 0
    v_add_u32 v86, s47, v1
    v_mov_b32 v88, s62
    v_mov_b32 v89, s62
    v_mov_b32 v90, s62
    v_mov_b32 v91, s62
    ds_read_b128 v[24:27], v86 offset:0
    ds_read_b128 v[28:31], v86 offset:1024
    ds_read_b128 v[32:35], v86 offset:2048
    ds_read_b128 v[36:39], v86 offset:3072
    ds_read_b128 v[40:43], v86 offset:4096
    ds_read_b128 v[44:47], v86 offset:5120
    ds_read_b128 v[48:51], v86 offset:6144
    ds_read_b128 v[52:55], v86 offset:7168
    s_waitcnt lgkmcnt(7)
    v_mfma_f32_16x16x32_bf16 v[92:95], v[88:91], v[24:27], 0
    ds_read_b128 v[24:27], v86 offset:8192
    s_waitcnt lgkmcnt(7)
    v_mfma_f32_16x16x32_bf16 v[92:95], v[88:91], v[28:31], v[92:95]
    ds_read_b128 v[28:31], v86 offset:9216
    s_waitcnt lgkmcnt(7)
    v_mfma_f32_16x16x32_bf16 v[92:95], v[88:91], v[32:35], v[92:95]
    ds_read_b128 v[32:35], v86 offset:10240
    s_waitcnt lgkmcnt(7)
    v_mfma_f32_16x16x32_bf16 v[92:95], v[88:91], v[36:39], v[92:95]
    ds_read_b128 v[36:39], v86 offset:11264
    s_waitcnt lgkmcnt(7)
    v_mfma_f32_16x16x32_bf16 v[92:95], v[88:91], v[40:43], v[92:95]
    ds_read_b128 v[40:43], v86 offset:12288
    s_waitcnt lgkmcnt(7)
    v_mfma_f32_16x16x32_bf16 v[92:95], v[88:91], v[44:47], v[92:95]
    ds_read_b128 v[44:47], v86 offset:13312
    s_waitcnt lgkmcnt(7)
    v_mfma_f32_16x16x32_bf16 v[92:95], v[88:91], v[48:51], v[92:95]
    ds_read_b128 v[48:51], v86 offset:14336
    s_waitcnt lgkmcnt(7)
    v_mfma_f32_16x16x32_bf16 v[92:95], v[88:91], v[52:55], v[92:95]
    ds_read_b128 v[52:55], v86 offset:15360
    s_waitcnt lgkmcnt(7)
    v_mfma_f32_16x16x32_bf16 v[92:95], v[88:91], v[24:27], v[92:95]
    s_waitcnt lgkmcnt(6)
    v_mfma_f32_16x16x32_bf16 v[92:95], v[88:91], v[28:31], v[92:95]
    s_waitcnt lgkmcnt(5)
    v_mfma_f32_16x16x32_bf16 v[92:95], v[88:91], v[32:35], v[92:95]
    s_waitcnt lgkmcnt(4)
    v_mfma_f32_16x16x32_bf16 v[92:95], v[88:91], v[36:39], v[92:95]
    s_waitcnt lgkmcnt(3)
    v_mfma_f32_16x16x32_bf16 v[92:95], v[88:91], v[40:43], v[92:95]
    s_waitcnt lgkmcnt(2)
    v_mfma_f32_16x16x32_bf16 v[92:95], v[88:91], v[44:47], v[92:95]
    s_waitcnt lgkmcnt(1)
    v_mfma_f32_16x16x32_bf16 v[92:95], v[88:91], v[48:51], v[92:95]
    s_waitcnt lgkmcnt(0)
    v_mfma_f32_16x16x32_bf16 v[92:95], v[88:91], v[52:55], v[92:95]
    v_lshlrev_b32 v86, 2, v81
    s_lshl_b32 s47, s48, 6
    s_add_u32 s47, s47, 159744
    v_add_u32 v86, s47, v86
    s_nop 3
    ds_write_b32 v86, v92
    s_waitcnt lgkmcnt(0)
    s_lshl_b32 s47, s48, 2
    s_add_u32 s47, s47, 162816
    v_mov_b32 v86, s47
    v_mov_b32 v87, 1
    ds_write_b32 v86, v87
    s_waitcnt lgkmcnt(0)
L_nocs_8:
    s_setprio 2
    ds_read_b128 v[24:27], v1 offset:8192
    ds_read_b128 v[28:31], v1 offset:24576
    ds_read_b128 v[32:35], v1 offset:40960
    ds_read_b128 v[36:39], v1 offset:57344
    ds_read_b128 v[40:43], v1 offset:9216
    ds_read_b128 v[44:47], v1 offset:25600
    s_waitcnt lgkmcnt(5)
    v_mfma_f32_16x16x32_bf16 v[56:59], v[136:139], v[24:27], v[56:59]
    ds_read_b128 v[48:51], v1 offset:41984
    s_waitcnt lgkmcnt(5)
    v_mfma_f32_16x16x32_bf16 v[60:63], v[136:139], v[28:31], v[60:63]
    ds_read_b128 v[52:55], v1 offset:58368
    s_waitcnt lgkmcnt(5)
    v_mfma_f32_16x16x32_bf16 v[64:67], v[136:139], v[32:35], v[64:67]
    ds_read_b128 v[24:27], v1 offset:10240
    s_waitcnt lgkmcnt(5)
    v_mfma_f32_16x16x32_bf16 v[68:71], v[136:139], v[36:39], v[68:71]
    ds_read_b128 v[28:31], v1 offset:26624
    s_waitcnt lgkmcnt(5)
    v_mfma_f32_16x16x32_bf16 v[56:59], v[140:143], v[40:43], v[56:59]
    ds_read_b128 v[32:35], v1 offset:43008
    s_waitcnt lgkmcnt(5)
    v_mfma_f32_16x16x32_bf16 v[60:63], v[140:143], v[44:47], v[60:63]
    ds_read_b128 v[36:39], v1 offset:59392
    s_waitcnt lgkmcnt(5)
    v_mfma_f32_16x16x32_bf16 v[64:67], v[140:143], v[48:51], v[64:67]
    ds_read_b128 v[40:43], v1 offset:11264
    s_waitcnt lgkmcnt(5)
    v_mfma_f32_16x16x32_bf16 v[68:71], v[140:143], v[52:55], v[68:71]
    ds_read_b128 v[44:47], v1 offset:27648
    s_waitcnt lgkmcnt(5)
    v_mfma_f32_16x16x32_bf16 v[56:59], v[144:147], v[24:27], v[56:59]
    ds_read_b128 v[48:51], v1 offset:44032
    s_waitcnt lgkmcnt(5)
    v_mfma_f32_16x16x32_bf16 v[60:63], v[144:147], v[28:31], v[60:63]
    ds_read_b128 v[52:55], v1 offset:60416
    s_waitcnt lgkmcnt(5)
    v_mfma_f32_16x16x32_bf16 v[64:67], v[144:147], v[32:35], v[64:67]
    ds_read_b128 v[24:27], v1 offset:12288
    s_waitcnt lgkmcnt(5)
    v_mfma_f32_16x16x32_bf16 v[68:71], v[144:147], v[36:39], v[68:71]
    ds_read_b128 v[28:31], v1 offset:28672
    s_waitcnt lgkmcnt(5)
    v_mfma_f32_16x16x32_bf16 v[56:59], v[148:151], v[40:43], v[56:59]
    ds_read_b128 v[32:35], v1 offset:45056
    s_waitcnt lgkmcnt(5)
    v_mfma_f32_16x16x32_bf16 v[60:63], v[148:151], v[44:47], v[60:63]
    ds_read_b128 v[36:39], v1 offset:61440
    s_waitcnt lgkmcnt(5)
    v_mfma_f32_16x16x32_bf16 v[64:67], v[148:151], v[48:51], v[64:67]
    ds_read_b128 v[40:43], v1 offset:13312
    s_waitcnt lgkmcnt(5)
    v_mfma_f32_16x16x32_bf16 v[68:71], v[148:151], v[52:55], v[68:71]
    ds_read_b128 v[44:47], v1 offset:29696
    s_waitcnt lgkmcnt(5)
    v_mfma_f32_16x16x32_bf16 v[56:59], v[152:155], v[24:27], v[56:59]
    ds_read_b128 v[48:51], v1 offset:46080
    s_waitcnt lgkmcnt(5)
    v_mfma_f32_16x16x32_bf16 v[60:63], v[152:155], v[28:31], v[60:63]
    ds_read_b128 v[52:55], v1 offset:62464
    s_waitcnt lgkmcnt(5)
    v_mfma_f32_16x16x32_bf16 v[64:67], v[152:155], v[32:35], v[64:67]
    ds_read_b128 v[24:27], v1 offset:14336
    s_waitcnt lgkmcnt(5)
    v_mfma_f32_16x16x32_bf16 v[68:71], v[152:155], v[36:39], v[68:71]
    ds_read_b128 v[28:31], v1 offset:30720
    s_waitcnt lgkmcnt(5)
    v_mfma_f32_16x16x32_bf16 v[56:59], v[156:159], v[40:43], v[56:59]
    ds_read_b128 v[32:35], v1 offset:47104
    s_waitcnt lgkmcnt(5)
    v_mfma_f32_16x16x32_bf16 v[60:63], v[156:159], v[44:47], v[60:63]
    ds_read_b128 v[36:39], v1 offset:63488
    s_waitcnt lgkmcnt(5)
    v_mfma_f32_16x16x32_bf16 v[64:67], v[156:159], v[48:51], v[64:67]
    ds_read_b128 v[40:43], v1 offset:15360
    s_waitcnt lgkmcnt(5)
    v_mfma_f32_16x16x32_bf16 v[68:71], v[156:159], v[52:55], v[68:71]
    ds_read_b128 v[44:47], v1 offset:31744
    s_waitcnt lgkmcnt(5)
    v_mfma_f32_16x16x32_bf16 v[56:59], v[160:163], v[24:27], v[56:59]
    ds_read_b128 v[48:51], v1 offset:48128
    s_waitcnt lgkmcnt(5)
    v_mfma_f32_16x16x32_bf16 v[60:63], v[160:163], v[28:31], v[60:63]
    ds_read_b128 v[52:55], v1 offset:64512
    s_waitcnt lgkmcnt(5)
    v_mfma_f32_16x16x32_bf16 v[64:67], v[160:163], v[32:35], v[64:67]
    s_waitcnt lgkmcnt(4)
    v_mfma_f32_16x16x32_bf16 v[68:71], v[160:163], v[36:39], v[68:71]
    s_waitcnt lgkmcnt(3)
    v_mfma_f32_16x16x32_bf16 v[56:59], v[164:167], v[40:43], v[56:59]
    s_waitcnt lgkmcnt(2)
    v_mfma_f32_16x16x32_bf16 v[60:63], v[164:167], v[44:47], v[60:63]
    s_waitcnt lgkmcnt(1)
    v_mfma_f32_16x16x32_bf16 v[64:67], v[164:167], v[48:51], v[64:67]
    s_waitcnt lgkmcnt(0)
    v_mfma_f32_16x16x32_bf16 v[68:71], v[164:167], v[52:55], v[68:71]
    s_setprio 0
    v_lshlrev_b32 v86, 4, v82
    v_lshlrev_b32 v87, 2, v81
    v_add_u32 v87, 159744, v87
    v_mov_b32 v100, 162816
    s_mov_b32 s57, 0
L_csw:
    ds_read_b128 v[96:99], v100
    s_add_u32 s57, s57, 1
    s_cmp_gt_u32 s57, 100000
    s_cbranch_scc1 L_cswx
    s_waitcnt lgkmcnt(0)
    v_and_b32 v96, v96, v97
    v_and_b32 v98, v98, v99
    v_and_b32 v96, v96, v98
    v_cmp_ne_u32 vcc, 0, v96
    s_cbranch_vccz L_csw
L_cswx:
    s_waitcnt lgkmcnt(0)
    ds_read_b32 v96, v87 offset:0
    ds_read_b32 v97, v87 offset:64
    ds_read_b32 v98, v87 offset:128
    ds_read_b32 v99, v87 offset:192
    v_mov_b32 v32, s62
    v_mov_b32 v33, s62
    v_add_u32 v34, s3, v1
    v_add_u32 v35, s3, v86
    s_waitcnt lgkmcnt(0)
    v_mul_f32 v100, v220, v96
    v_mul_f32 v101, v221, v96
    v_mul_f32 v102, v222, v96
    v_mul_f32 v103, v223, v96
    v_fma_f32 v56, v56, v216, -v100
    v_fma_f32 v57, v57, v217, -v101
    v_fma_f32 v58, v58, v218, -v102
    v_fma_f32 v59, v59, v219, -v103
    v_min_f32 v100, 0, v56
    v_min_f32 v101, 0, v57
    v_mul_f32 v100, 0x3fb8aa3b, v100
    v_mul_f32 v101, 0x3fb8aa3b, v101
    v_exp_f32 v100, v100
    v_exp_f32 v101, v101
    v_max_f32 v56, 0, v56
    v_max_f32 v57, 0, v57
    v_add_f32 v56, 0x358637bd, v56
    v_add_f32 v57, 0x358637bd, v57
    v_add_f32 v56, v56, v100
    v_add_f32 v57, v57, v101
    v_min_f32 v102, 0, v58
    v_min_f32 v103, 0, v59
    v_mul_f32 v102, 0x3fb8aa3b, v102
    v_mul_f32 v103, 0x3fb8aa3b, v103
    v_exp_f32 v102, v102
    v_exp_f32 v103, v103
    v_max_f32 v58, 0, v58
    v_max_f32 v59, 0, v59
    v_add_f32 v58, 0x358637bd, v58
    v_add_f32 v59, 0x358637bd, v59
    v_add_f32 v58, v58, v102
    v_add_f32 v59, v59, v103
    v_cvt_pk_bf16_f32 v24, v56, v57
    v_cvt_pk_bf16_f32 v25, v58, v59
    v_mul_f32 v100, v220, v97
    v_mul_f32 v101, v221, v97
    v_mul_f32 v102, v222, v97
    v_mul_f32 v103, v223, v97
    v_fma_f32 v60, v60, v216, -v100
    v_fma_f32 v61, v61, v217, -v101
    v_fma_f32 v62, v62, v218, -v102
    v_fma_f32 v63, v63, v219, -v103
    v_min_f32 v100, 0, v60
    v_min_f32 v101, 0, v61
    v_mul_f32 v100, 0x3fb8aa3b, v100
    v_mul_f32 v101, 0x3fb8aa3b, v101
    v_exp_f32 v100, v100
    v_exp_f32 v101, v101
    v_max_f32 v60, 0, v60
    v_max_f32 v61, 0, v61
    v_add_f32 v60, 0x358637bd, v60
    v_add_f32 v61, 0x358637bd, v61
    v_add_f32 v60, v60, v100
    v_add_f32 v61, v61, v101
    v_min_f32 v102, 0, v62
    v_min_f32 v103, 0, v63
    v_mul_f32 v102, 0x3fb8aa3b, v102
    v_mul_f32 v103, 0x3fb8aa3b, v103
    v_exp_f32 v102, v102
    v_exp_f32 v103, v103
    v_max_f32 v62, 0, v62
    v_max_f32 v63, 0, v63
    v_add_f32 v62, 0x358637bd, v62
    v_add_f32 v63, 0x358637bd, v63
    v_add_f32 v62, v62, v102
    v_add_f32 v63, v63, v103
    v_cvt_pk_bf16_f32 v26, v60, v61
    v_cvt_pk_bf16_f32 v27, v62, v63
    v_mul_f32 v100, v220, v98
    v_mul_f32 v101, v221, v98
    v_mul_f32 v102, v222, v98
    v_mul_f32 v103, v223, v98
    v_fma_f32 v64, v64, v216, -v100
    v_fma_f32 v65, v65, v217, -v101
    v_fma_f32 v66, v66, v218, -v102
    v_fma_f32 v67, v67, v219, -v103
    v_cvt_pk_bf16_f32 v28, v64, v65
    v_cvt_pk_bf16_f32 v29, v66, v67
    v_mul_f32 v100, v220, v99
    v_mul_f32 v101, v221, v99
    v_mul_f32 v102, v222, v99
    v_mul_f32 v103, v223, v99
    v_fma_f32 v68, v68, v216, -v100
    v_fma_f32 v69, v69, v217, -v101
    v_fma_f32 v70, v70, v218, -v102
    v_fma_f32 v71, v71, v219, -v103
    v_cvt_pk_bf16_f32 v30, v68, v69
    v_cvt_pk_bf16_f32 v31, v70, v71
    v_mfma_f32_16x16x16_bf16 v[56:59], v[24:25], v[28:29], 0
    s_nop 0
    v_mfma_f32_16x16x16_bf16 v[60:63], v[26:27], v[30:31], 0
    v_mfma_f32_16x16x16_bf16 v[64:67], v[24:25], v[32:33], 0
    v_mfma_f32_16x16x16_bf16 v[68:71], v[26:27], v[32:33], 0
    s_nop 3
    ds_write_b128 v34, v[56:59] offset:0
    s_nop 0
    ds_write_b128 v34, v[60:63] offset:1024
    ds_write_b128 v35, v[64:67] offset:2048
    ds_write_b128 v35, v[68:71] offset:2112
    s_waitcnt vmcnt(0) lgkmcnt(0)
    s_barrier
    s_cmp_lt_u32 s46, 3
    s_cbranch_scc1 L_nokvred
    s_cmp_eq_u32 s46, 3
    s_cbranch_scc1 L_zred
    v_lshlrev_b32 v87, 3, v80
    s_sub_u32 s48, s46, 4
    s_lshl_b32 s48, s48, 9
    s_add_u32 s47, s48, 98304
    v_add_u32 v86, s47, v87
    ds_read_b64 v[24:25], v86 offset:0
    ds_read_b64 v[26:27], v86 offset:4096
    ds_read_b64 v[28:29], v86 offset:8192
    ds_read_b64 v[30:31], v86 offset:12288
    ds_read_b64 v[32:33], v86 offset:16384
    ds_read_b64 v[34:35], v86 offset:20480
    ds_read_b64 v[36:37], v86 offset:24576
    ds_read_b64 v[38:39], v86 offset:28672
    s_lshl_b32 s49, s45, 4
    s_add_u32 s49, s49, s44
    s_lshl_b32 s49, s49, 11
    s_add_u32 s49, s49, s48
    s_add_u32 s49, s49, 262144
    s_waitcnt lgkmcnt(0)
    v_add_f32 v24, v24, v26
    v_add_f32 v25, v25, v27
    v_add_f32 v28, v28, v30
    v_add_f32 v29, v29, v31
    v_add_f32 v32, v32, v34
    v_add_f32 v33, v33, v35
    v_add_f32 v36, v36, v38
    v_add_f32 v37, v37, v39
    v_add_f32 v24, v24, v28
    v_add_f32 v25, v25, v29
    v_add_f32 v32, v32, v36
    v_add_f32 v33, v33, v37
    v_add_f32 v24, v24, v32
    v_add_f32 v25, v25, v33
    buffer_store_dwordx2 v[24:25], v87, s[40:43], s49 offen sc1
    s_branch L_kvflag
L_zred:
    v_and_b32 v87, 31, v80
    v_lshlrev_b32 v87, 2, v87
    v_add_u32 v86, 100352, v87
    ds_read_b32 v24, v86 offset:0
    ds_read_b32 v25, v86 offset:4096
    ds_read_b32 v26, v86 offset:8192
    ds_read_b32 v27, v86 offset:12288
    ds_read_b32 v28, v86 offset:16384
    ds_read_b32 v29, v86 offset:20480
    ds_read_b32 v30, v86 offset:24576
    ds_read_b32 v31, v86 offset:28672
    s_lshl_b32 s49, s45, 4
    s_add_u32 s49, s49, s44
    s_lshl_b32 s49, s49, 7
    s_add_u32 s49, s49, 786432
    s_waitcnt lgkmcnt(0)
    v_add_f32 v24, v24, v25
    v_add_f32 v24, v24, v26
    v_add_f32 v24, v24, v27
    v_add_f32 v24, v24, v28
    v_add_f32 v24, v24, v29
    v_add_f32 v24, v24, v30
    v_add_f32 v24, v24, v31
    buffer_store_dword v24, v87, s[40:43], s49 offen sc1
L_kvflag:
    s_lshl_b32 s47, s45, 4
    s_add_u32 s47, s47, s44
    s_add_u32 s47, s47, 0
    s_lshl_b32 s47, s47, 7
    s_lshl_b32 s48, s46, 3
    s_add_u32 s47, s47, s48
    v_mov_b32 v14, s59
    v_not_b32 v15, s59
    s_mov_b64 s[90:91], exec
    s_mov_b64 exec, 1
    s_waitcnt vmcnt(0)
    buffer_store_dwordx2 v[14:15], v7, s[40:43], s47 offen sc1
    s_mov_b64 exec, s[90:91]
L_nokvred:
    s_cmp_ge_u32 s46, 4
    s_cbranch_scc1 L_norf
L_a03:
    s_lshr_b32 s47, s45, 3
    s_mul_i32 s49, s45, 98304
    s_lshl_b32 s48, s44, 10
    s_add_u32 s49, s49, s48
    s_lshl_b32 s48, s46, 16
    s_add_u32 s49, s49, s48
    s_add_u32 s49, s49, 13631488
    s_mov_b32 s51, 16384
    s_cmp_lt_u32 s46, 2
    s_cbranch_scc1 L_rpdst
    s_mov_b32 s51, 1024
    s_add_u32 s48, s47, s46
    s_lshl_b32 s49, s7, 16
    s_lshl_b32 s50, s44, 12
    s_add_u32 s49, s49, s50
    s_add_u32 s49, s49, 15204352
    s_cmp_eq_u32 s48, 2
    s_cbranch_scc1 L_rpdst
    s_sub_u32 s48, s46, 1
    s_mul_i32 s48, s48, s47
    s_lshl_b32 s48, s48, 4
    s_add_u32 s48, s48, s44
    s_min_u32 s48, s48, 43
    s_lshl_b32 s48, s48, 12
    s_mul_i32 s49, s7, 180224
    s_add_u32 s49, s49, s48
    s_add_u32 s49, s49, 15728640
L_rpdst:
    s_waitcnt vmcnt(0)
    s_lshl_b32 s47, s46, 12
    s_add_u32 s47, s47, 131072
    v_lshlrev_b32 v86, 8, v11
    v_lshl_add_u32 v86, v12, 3, v86
    v_add_u32 v86, s47, v86
    v_add_u32 v87, s47, v1
    s_cmp_eq_u32 s46, 1
    s_cselect_b32 s47, 0, 1
    v_mul_lo_u32 v88, v9, s47
    v_lshl_add_u32 v86, v88, 11, v86
    v_lshl_add_u32 v86, v83, 6, v86
    v_perm_b32 v24, v196, v192, s60
    v_perm_b32 v26, v196, v192, s61
    v_perm_b32 v25, v204, v200, s60
    v_perm_b32 v27, v204, v200, s61
    v_perm_b32 v28, v197, v193, s60
    v_perm_b32 v30, v197, v193, s61
    v_perm_b32 v29, v205, v201, s60
    v_perm_b32 v31, v205, v201, s61
    v_perm_b32 v32, v198, v194, s60
    v_perm_b32 v34, v198, v194, s61
    v_perm_b32 v33, v206, v202, s60
    v_perm_b32 v35, v206, v202, s61
    v_perm_b32 v36, v199, v195, s60
    v_perm_b32 v38, v199, v195, s61
    v_perm_b32 v37, v207, v203, s60
    v_perm_b32 v39, v207, v203, s61
    ds_write_b64 v86, v[24:25] offset:0
    ds_write_b64 v86, v[26:27] offset:16
    ds_write_b64 v86, v[28:29] offset:32
    ds_write_b64 v86, v[30:31] offset:48
    ds_write_b64 v86, v[32:33] offset:1024
    ds_write_b64 v86, v[34:35] offset:1040
    ds_write_b64 v86, v[36:37] offset:1056
    ds_write_b64 v86, v[38:39] offset:1072
    s_waitcnt lgkmcnt(0)
    ds_read_b128 v[40:43], v87 offset:0
    ds_read_b128 v[44:47], v87 offset:1024
    ds_read_b128 v[48:51], v87 offset:2048
    ds_read_b128 v[52:55], v87 offset:3072
    s_waitcnt lgkmcnt(0)
    buffer_store_dwordx4 v[40:43], v1, s[40:43], s49 offen sc1
    s_add_u32 s49, s49, s51
    buffer_store_dwordx4 v[44:47], v1, s[40:43], s49 offen sc1
    s_add_u32 s49, s49, s51
    s_cmp_eq_u32 s46, 1
    s_cbranch_scc1 L_asf_9
    buffer_store_dwordx4 v[48:51], v1, s[40:43], s49 offen sc1
    s_add_u32 s49, s49, s51
    buffer_store_dwordx4 v[52:55], v1, s[40:43], s49 offen sc1
L_asf_9:
    s_lshl_b32 s47, s45, 4
    s_add_u32 s47, s47, s44
    s_add_u32 s47, s47, 1024
    s_lshl_b32 s47, s47, 7
    s_lshl_b32 s48, s46, 3
    s_add_u32 s47, s47, s48
    v_mov_b32 v14, s59
    v_not_b32 v15, s59
    s_mov_b64 s[90:91], exec
    s_mov_b64 exec, 1
    s_waitcnt vmcnt(0)
    buffer_store_dwordx2 v[14:15], v7, s[40:43], s47 offen sc1
    s_mov_b64 exec, s[90:91]
L_norf:
    s_cmp_lt_u32 s46, 4
    s_cbranch_scc1 L_nocs_10
    s_cmp_ge_u32 s46, 6
    s_cbranch_scc1 L_nocs_10
    s_add_u32 s48, s46, 0
    s_lshl_b32 s47, s48, 14
    s_add_u32 s47, s47, 0
    v_add_u32 v86, s47, v1
    v_mov_b32 v88, s62
    v_mov_b32 v89, s62
    v_mov_b32 v90, s62
    v_mov_b32 v91, s62
    ds_read_b128 v[24:27], v86 offset:0
    ds_read_b128 v[28:31], v86 offset:1024
    ds_read_b128 v[32:35], v86 offset:2048
    ds_read_b128 v[36:39], v86 offset:3072
    ds_read_b128 v[40:43], v86 offset:4096
    ds_read_b128 v[44:47], v86 offset:5120
    ds_read_b128 v[48:51], v86 offset:6144
    ds_read_b128 v[52:55], v86 offset:7168
    s_waitcnt lgkmcnt(7)
    v_mfma_f32_16x16x32_bf16 v[92:95], v[88:91], v[24:27], 0
    ds_read_b128 v[24:27], v86 offset:8192
    s_waitcnt lgkmcnt(7)
    v_mfma_f32_16x16x32_bf16 v[92:95], v[88:91], v[28:31], v[92:95]
    ds_read_b128 v[28:31], v86 offset:9216
    s_waitcnt lgkmcnt(7)
    v_mfma_f32_16x16x32_bf16 v[92:95], v[88:91], v[32:35], v[92:95]
    ds_read_b128 v[32:35], v86 offset:10240
    s_waitcnt lgkmcnt(7)
    v_mfma_f32_16x16x32_bf16 v[92:95], v[88:91], v[36:39], v[92:95]
    ds_read_b128 v[36:39], v86 offset:11264
    s_waitcnt lgkmcnt(7)
    v_mfma_f32_16x16x32_bf16 v[92:95], v[88:91], v[40:43], v[92:95]
    ds_read_b128 v[40:43], v86 offset:12288
    s_waitcnt lgkmcnt(7)
    v_mfma_f32_16x16x32_bf16 v[92:95], v[88:91], v[44:47], v[92:95]
    ds_read_b128 v[44:47], v86 offset:13312
    s_waitcnt lgkmcnt(7)
    v_mfma_f32_16x16x32_bf16 v[92:95], v[88:91], v[48:51], v[92:95]
    ds_read_b128 v[48:51], v86 offset:14336
    s_waitcnt lgkmcnt(7)
    v_mfma_f32_16x16x32_bf16 v[92:95], v[88:91], v[52:55], v[92:95]
    ds_read_b128 v[52:55], v86 offset:15360
    s_waitcnt lgkmcnt(7)
    v_mfma_f32_16x16x32_bf16 v[92:95], v[88:91], v[24:27], v[92:95]
    s_waitcnt lgkmcnt(6)
    v_mfma_f32_16x16x32_bf16 v[92:95], v[88:91], v[28:31], v[92:95]
    s_waitcnt lgkmcnt(5)
    v_mfma_f32_16x16x32_bf16 v[92:95], v[88:91], v[32:35], v[92:95]
    s_waitcnt lgkmcnt(4)
    v_mfma_f32_16x16x32_bf16 v[92:95], v[88:91], v[36:39], v[92:95]
    s_waitcnt lgkmcnt(3)
    v_mfma_f32_16x16x32_bf16 v[92:95], v[88:91], v[40:43], v[92:95]
    s_waitcnt lgkmcnt(2)
    v_mfma_f32_16x16x32_bf16 v[92:95], v[88:91], v[44:47], v[92:95]
    s_waitcnt lgkmcnt(1)
    v_mfma_f32_16x16x32_bf16 v[92:95], v[88:91], v[48:51], v[92:95]
    s_waitcnt lgkmcnt(0)
    v_mfma_f32_16x16x32_bf16 v[92:95], v[88:91], v[52:55], v[92:95]
    v_lshlrev_b32 v86, 2, v81
    s_lshl_b32 s47, s48, 6
    s_add_u32 s47, s47, 159744
    v_add_u32 v86, s47, v86
    s_nop 3
    ds_write_b32 v86, v92
    s_waitcnt lgkmcnt(0)
L_nocs_10:
    s_setprio 2
    ds_read_b128 v[24:27], v3 offset:0
    ds_read_b128 v[28:31], v3 offset:16384
    ds_read_b128 v[32:35], v3 offset:1024
    ds_read_b128 v[36:39], v3 offset:17408
    ds_read_b128 v[40:43], v3 offset:2048
    ds_read_b128 v[44:47], v3 offset:18432
    s_waitcnt lgkmcnt(5)
    v_mfma_f32_16x16x32_bf16 v[72:75], v[24:27], v[104:107], 0
    ds_read_b128 v[48:51], v3 offset:3072
    s_waitcnt lgkmcnt(5)
    v_mfma_f32_16x16x32_bf16 v[76:79], v[28:31], v[104:107], 0
    ds_read_b128 v[52:55], v3 offset:19456
    s_waitcnt lgkmcnt(5)
    v_mfma_f32_16x16x32_bf16 v[72:75], v[32:35], v[108:111], v[72:75]
    ds_read_b128 v[24:27], v3 offset:4096
    s_waitcnt lgkmcnt(5)
    v_mfma_f32_16x16x32_bf16 v[76:79], v[36:39], v[108:111], v[76:79]
    ds_read_b128 v[28:31], v3 offset:20480
    s_waitcnt lgkmcnt(5)
    v_mfma_f32_16x16x32_bf16 v[72:75], v[40:43], v[112:115], v[72:75]
    ds_read_b128 v[32:35], v3 offset:5120
    s_waitcnt lgkmcnt(5)
    v_mfma_f32_16x16x32_bf16 v[76:79], v[44:47], v[112:115], v[76:79]
    ds_read_b128 v[36:39], v3 offset:21504
    s_waitcnt lgkmcnt(5)
    v_mfma_f32_16x16x32_bf16 v[72:75], v[48:51], v[116:119], v[72:75]
    ds_read_b128 v[40:43], v3 offset:6144
    s_waitcnt lgkmcnt(5)
    v_mfma_f32_16x16x32_bf16 v[76:79], v[52:55], v[116:119], v[76:79]
    ds_read_b128 v[44:47], v3 offset:22528
    s_waitcnt lgkmcnt(5)
    v_mfma_f32_16x16x32_bf16 v[72:75], v[24:27], v[120:123], v[72:75]
    ds_read_b128 v[48:51], v3 offset:7168
    s_waitcnt lgkmcnt(5)
    v_mfma_f32_16x16x32_bf16 v[76:79], v[28:31], v[120:123], v[76:79]
    ds_read_b128 v[52:55], v3 offset:23552
    s_waitcnt lgkmcnt(5)
    v_mfma_f32_16x16x32_bf16 v[72:75], v[32:35], v[124:127], v[72:75]
    ds_read_b128 v[24:27], v3 offset:8192
    s_waitcnt lgkmcnt(5)
    v_mfma_f32_16x16x32_bf16 v[76:79], v[36:39], v[124:127], v[76:79]
    ds_read_b128 v[28:31], v3 offset:24576
    s_waitcnt lgkmcnt(5)
    v_mfma_f32_16x16x32_bf16 v[72:75], v[40:43], v[128:131], v[72:75]
    ds_read_b128 v[32:35], v3 offset:9216
    s_waitcnt lgkmcnt(5)
    v_mfma_f32_16x16x32_bf16 v[76:79], v[44:47], v[128:131], v[76:79]
    ds_read_b128 v[36:39], v3 offset:25600
    s_waitcnt lgkmcnt(5)
    v_mfma_f32_16x16x32_bf16 v[72:75], v[48:51], v[132:135], v[72:75]
    ds_read_b128 v[40:43], v3 offset:10240
    s_waitcnt lgkmcnt(5)
    v_mfma_f32_16x16x32_bf16 v[76:79], v[52:55], v[132:135], v[76:79]
    ds_read_b128 v[44:47], v3 offset:26624
    s_waitcnt lgkmcnt(5)
    v_mfma_f32_16x16x32_bf16 v[72:75], v[24:27], v[136:139], v[72:75]
    ds_read_b128 v[48:51], v3 offset:11264
    s_waitcnt lgkmcnt(5)
    v_mfma_f32_16x16x32_bf16 v[76:79], v[28:31], v[136:139], v[76:79]
    ds_read_b128 v[52:55], v3 offset:27648
    s_waitcnt lgkmcnt(5)
    v_mfma_f32_16x16x32_bf16 v[72:75], v[32:35], v[140:143], v[72:75]
    ds_read_b128 v[24:27], v3 offset:12288
    s_waitcnt lgkmcnt(5)
    v_mfma_f32_16x16x32_bf16 v[76:79], v[36:39], v[140:143], v[76:79]
    ds_read_b128 v[28:31], v3 offset:28672
    s_waitcnt lgkmcnt(5)
    v_mfma_f32_16x16x32_bf16 v[72:75], v[40:43], v[144:147], v[72:75]
    ds_read_b128 v[32:35], v3 offset:13312
    s_waitcnt lgkmcnt(5)
    v_mfma_f32_16x16x32_bf16 v[76:79], v[44:47], v[144:147], v[76:79]
    ds_read_b128 v[36:39], v3 offset:29696
    s_waitcnt lgkmcnt(5)
    v_mfma_f32_16x16x32_bf16 v[72:75], v[48:51], v[148:151], v[72:75]
    ds_read_b128 v[40:43], v3 offset:14336
    s_waitcnt lgkmcnt(5)
    v_mfma_f32_16x16x32_bf16 v[76:79], v[52:55], v[148:151], v[76:79]
    ds_read_b128 v[44:47], v3 offset:30720
    s_waitcnt lgkmcnt(5)
    v_mfma_f32_16x16x32_bf16 v[72:75], v[24:27], v[152:155], v[72:75]
    ds_read_b128 v[48:51], v3 offset:15360
    s_waitcnt lgkmcnt(5)
    v_mfma_f32_16x16x32_bf16 v[76:79], v[28:31], v[152:155], v[76:79]
    ds_read_b128 v[52:55], v3 offset:31744
    s_waitcnt lgkmcnt(5)
    v_mfma_f32_16x16x32_bf16 v[72:75], v[32:35], v[156:159], v[72:75]
    s_waitcnt lgkmcnt(4)
    v_mfma_f32_16x16x32_bf16 v[76:79], v[36:39], v[156:159], v[76:79]
    s_waitcnt lgkmcnt(3)
    v_mfma_f32_16x16x32_bf16 v[72:75], v[40:43], v[160:163], v[72:75]
    s_waitcnt lgkmcnt(2)
    v_mfma_f32_16x16x32_bf16 v[76:79], v[44:47], v[160:163], v[76:79]
    s_waitcnt lgkmcnt(1)
    v_mfma_f32_16x16x32_bf16 v[72:75], v[48:51], v[164:167], v[72:75]
    s_waitcnt lgkmcnt(0)
    v_mfma_f32_16x16x32_bf16 v[76:79], v[52:55], v[164:167], v[76:79]
    s_setprio 0
    s_barrier
    v_lshlrev_b32 v86, 4, v82
    v_add_u32 v86, 159744, v86
    ds_read_b128 v[88:91], v86 offset:256
    ds_read_b128 v[92:95], v86 offset:320
    v_lshlrev_b32 v87, 10, v81
    v_lshl_add_u32 v87, v82, 4, v87
    s_lshl_b32 s48, s53, 14
    s_add_u32 s48, s48, s52
    s_lshl_b32 s49, s54, 6
    s_add_u32 s48, s48, s49
    buffer_load_dwordx4 v[136:139], v87, s[8:11], s48 offen
    v_lshlrev_b32 v87, 4, v82
    s_add_u32 s49, s56, 0
    s_lshl_b32 s49, s49, 6
    buffer_load_dwordx4 v[240:243], v87, s[24:27], s49 offen
    s_add_u32 s49, s56, 1
    s_lshl_b32 s49, s49, 6
    buffer_load_dwordx4 v[244:247], v87, s[24:27], s49 offen
    s_add_u32 s49, s6, 0
    s_lshl_b32 s49, s49, 6
    buffer_load_dwordx4 v[248:251], v87, s[24:27], s49 offen
    s_waitcnt lgkmcnt(0)
    v_mul_f32 v100, v17, v88
    v_mul_f32 v101, v17, v89
    v_mul_f32 v102, v17, v90
    v_mul_f32 v103, v17, v91
    v_fma_f32 v72, v72, v18, -v100
    v_fma_f32 v73, v73, v18, -v101
    v_fma_f32 v74, v74, v18, -v102
    v_fma_f32 v75, v75, v18, -v103
    v_min_f32 v100, 0, v72
    v_min_f32 v101, 0, v73
    v_mul_f32 v100, 0x3fb8aa3b, v100
    v_mul_f32 v101, 0x3fb8aa3b, v101
    v_exp_f32 v100, v100
    v_exp_f32 v101, v101
    v_max_f32 v72, 0, v72
    v_max_f32 v73, 0, v73
    v_add_f32 v72, 0x358637bd, v72
    v_add_f32 v73, 0x358637bd, v73
    v_add_f32 v72, v72, v100
    v_add_f32 v73, v73, v101
    v_min_f32 v102, 0, v74
    v_min_f32 v103, 0, v75
    v_mul_f32 v102, 0x3fb8aa3b, v102
    v_mul_f32 v103, 0x3fb8aa3b, v103
    v_exp_f32 v102, v102
    v_exp_f32 v103, v103
    v_max_f32 v74, 0, v74
    v_max_f32 v75, 0, v75
    v_add_f32 v74, 0x358637bd, v74
    v_add_f32 v75, 0x358637bd, v75
    v_add_f32 v74, v74, v102
    v_add_f32 v75, v75, v103
    v_cvt_pk_bf16_f32 v20, v72, v73
    v_cvt_pk_bf16_f32 v21, v74, v75
    v_mul_f32 v100, v17, v92
    v_mul_f32 v101, v17, v93
    v_mul_f32 v102, v17, v94
    v_mul_f32 v103, v17, v95
    v_fma_f32 v76, v76, v18, -v100
    v_fma_f32 v77, v77, v18, -v101
    v_fma_f32 v78, v78, v18, -v102
    v_fma_f32 v79, v79, v18, -v103
    v_min_f32 v100, 0, v76
    v_min_f32 v101, 0, v77
    v_mul_f32 v100, 0x3fb8aa3b, v100
    v_mul_f32 v101, 0x3fb8aa3b, v101
    v_exp_f32 v100, v100
    v_exp_f32 v101, v101
    v_max_f32 v76, 0, v76
    v_max_f32 v77, 0, v77
    v_add_f32 v76, 0x358637bd, v76
    v_add_f32 v77, 0x358637bd, v77
    v_add_f32 v76, v76, v100
    v_add_f32 v77, v77, v101
    v_min_f32 v102, 0, v78
    v_min_f32 v103, 0, v79
    v_mul_f32 v102, 0x3fb8aa3b, v102
    v_mul_f32 v103, 0x3fb8aa3b, v103
    v_exp_f32 v102, v102
    v_exp_f32 v103, v103
    v_max_f32 v78, 0, v78
    v_max_f32 v79, 0, v79
    v_add_f32 v78, 0x358637bd, v78
    v_add_f32 v79, 0x358637bd, v79
    v_add_f32 v78, v78, v102
    v_add_f32 v79, v79, v103
    v_cvt_pk_bf16_f32 v22, v76, v77
    v_cvt_pk_bf16_f32 v23, v78, v79
    s_lshl_b32 s49, s45, 15
    s_and_b32 s48, s46, 1
    s_lshl_b32 s48, s48, 10
    s_add_u32 s49, s49, s48
    s_lshr_b32 s48, s46, 1
    s_lshl_b32 s48, s48, 13
    s_add_u32 s49, s49, s48
    s_add_u32 s49, s49, 262144
    s_cmp_lg_u32 s46, 0
    s_cbranch_scc1 L_pskip_11
    v_lshrrev_b32 v86, 2, v80
    v_lshlrev_b32 v86, 7, v86
    v_lshl_add_u32 v86, v83, 4, v86
    s_add_u32 s47, s45, 0
    s_lshl_b32 s47, s47, 11
    s_mov_b32 s57, 0
    s_not_b32 s48, s59
    v_cmp_gt_u32 vcc, 2, v83
    s_nop 1
    v_cndmask_b32 v92, -1, 0, vcc
    v_cmp_eq_u32 vcc, 0, v83
    s_nop 1
    v_cndmask_b32 v93, -1, 0, vcc
L_poll_12:
    buffer_load_dwordx4 v[88:91], v86, s[40:43], s47 offen sc1
    s_add_u32 s57, s57, 1
    s_waitcnt vmcnt(0)
    v_xor_b32 v88, s59, v88
    v_xor_b32 v89, s48, v89
    v_xor_b32 v90, s59, v90
    v_xor_b32 v91, s48, v91
    v_or_b32 v88, v88, v89
    v_or_b32 v90, v90, v91
    v_and_b32 v88, v88, v92
    v_and_b32 v90, v90, v93
    v_or_b32 v88, v88, v90
    v_cmp_eq_u32 vcc, 0, v88
    s_cmp_gt_u32 s57, 200000
    s_cbranch_scc1 L_pskip_11
    s_cmp_eq_u64 vcc, exec
    s_cbranch_scc0 L_poll_12
L_pskip_11:
    s_barrier
    buffer_load_dwordx4 v[24:27], v1, s[40:43], s49 offen offset:0 sc1
    buffer_load_dwordx4 v[28:31], v1, s[40:43], s49 offen offset:2048 sc1
    s_add_u32 s49, s49, 4096
    buffer_load_dwordx4 v[32:35], v1, s[40:43], s49 offen offset:0 sc1
    buffer_load_dwordx4 v[36:39], v1, s[40:43], s49 offen offset:2048 sc1
    s_cmp_lg_u32 s46, 7
    s_cbranch_scc1 L_noz
    s_lshl_b32 s49, s45, 11
    s_add_u32 s49, s49, 786432
    buffer_load_dwordx4 v[40:43], v1, s[40:43], s49 offen sc1
    buffer_load_dwordx4 v[44:47], v1, s[40:43], s49 offen offset:1024 sc1
    s_waitcnt vmcnt(0)
    v_add_f32 v40, v40, v44
    v_add_f32 v41, v41, v45
    v_add_f32 v42, v42, v46
    v_add_f32 v43, v43, v47
    v_add_f32_dpp v40, v40, v40 row_ror:8 row_mask:0xf bank_mask:0xf
    v_add_f32_dpp v41, v41, v41 row_ror:8 row_mask:0xf bank_mask:0xf
    v_add_f32_dpp v42, v42, v42 row_ror:8 row_mask:0xf bank_mask:0xf
    v_add_f32_dpp v43, v43, v43 row_ror:8 row_mask:0xf bank_mask:0xf
    v_mov_b32 v44, v40
    v_mov_b32 v45, v41
    v_mov_b32 v46, v42
    v_mov_b32 v47, v43
    v_permlane32_swap_b32 v40, v44
    v_permlane32_swap_b32 v41, v45
    v_permlane32_swap_b32 v42, v46
    v_permlane32_swap_b32 v43, v47
    v_add_f32 v40, v40, v44
    v_add_f32 v41, v41, v45
    v_add_f32 v42, v42, v46
    v_add_f32 v43, v43, v47
    v_mov_b32 v44, v40
    v_mov_b32 v45, v41
    v_mov_b32 v46, v42
    v_mov_b32 v47, v43
    v_permlane16_swap_b32 v40, v44
    v_permlane16_swap_b32 v41, v45
    v_permlane16_swap_b32 v42, v46
    v_permlane16_swap_b32 v43, v47
    v_add_f32 v40, v40, v44
    v_add_f32 v41, v41, v45
    v_add_f32 v42, v42, v46
    v_add_f32 v43, v43, v47
    v_cvt_pk_bf16_f32 v44, v40, v41
    v_cvt_pk_bf16_f32 v45, v42, v43
    v_and_b32 v86, 7, v80
    v_lshlrev_b32 v86, 3, v86
    v_add_u32 v86, 161792, v86
    ds_write_b64 v86, v[44:45]
L_noz:
    s_cmp_lg_u32 s46, 6
    s_cbranch_scc1 L_pskip_13
    v_lshrrev_b32 v86, 1, v80
    v_and_b32 v87, 15, v86
    v_lshrrev_b32 v86, 4, v86
    v_lshlrev_b32 v86, 3, v86
    v_xor_b32 v86, s45, v86
    v_lshl_add_u32 v86, v86, 4, v87
    v_lshlrev_b32 v86, 7, v86
    v_and_b32 v87, 1, v80
    v_lshl_add_u32 v86, v87, 4, v86
    s_mov_b32 s47, 131072
    s_mov_b32 s57, 0
    s_not_b32 s48, s59
L_poll_14:
    buffer_load_dwordx4 v[88:91], v86, s[40:43], s47 offen sc1
    s_add_u32 s57, s57, 1
    s_waitcnt vmcnt(0)
    v_xor_b32 v88, s59, v88
    v_xor_b32 v89, s48, v89
    v_xor_b32 v90, s59, v90
    v_xor_b32 v91, s48, v91
    v_or_b32 v88, v88, v89
    v_or_b32 v90, v90, v91
    v_or_b32 v88, v88, v90
    v_cmp_eq_u32 vcc, 0, v88
    s_cmp_gt_u32 s57, 200000
    s_cbranch_scc1 L_pskip_13
    s_cmp_eq_u64 vcc, exec
    s_cbranch_scc0 L_poll_14
L_pskip_13:
    s_lshl_b32 s47, s46, 10
    s_add_u32 s47, s47, 98304
    v_add_u32 v86, s47, v1
    v_add_u32 v87, 98304, v1
    s_waitcnt vmcnt(0)
    v_add_f32 v24, v24, v28
    v_add_f32 v32, v32, v36
    v_add_f32 v25, v25, v29
    v_add_f32 v33, v33, v37
    v_add_f32 v26, v26, v30
    v_add_f32 v34, v34, v38
    v_add_f32 v27, v27, v31
    v_add_f32 v35, v35, v39
    v_add_f32 v24, v24, v32
    v_add_f32 v25, v25, v33
    v_add_f32 v26, v26, v34
    v_add_f32 v27, v27, v35
    ds_write_b128 v86, v[24:27]
    s_waitcnt lgkmcnt(0)
    s_barrier
    ds_read_b128 v[24:27], v87 offset:0
    ds_read_b128 v[28:31], v87 offset:1024
    ds_read_b128 v[32:35], v87 offset:2048
    ds_read_b128 v[36:39], v87 offset:3072
    ds_read_b128 v[40:43], v87 offset:4096
    ds_read_b128 v[44:47], v87 offset:5120
    ds_read_b128 v[48:51], v87 offset:6144
    ds_read_b128 v[52:55], v87 offset:7168
    v_lshlrev_b32 v86, 3, v82
    v_add_u32 v86, 161792, v86
    ds_read_b64 v[92:93], v86 offset:0
    ds_read_b64 v[94:95], v86 offset:32
    s_lshl_b32 s49, s44, 3
    s_add_u32 s49, s49, s5
    s_lshl_b32 s49, s49, 4
    s_add_u32 s49, s49, s45
    s_lshl_b32 s49, s49, 10
    s_add_u32 s49, s49, 2097152
    s_waitcnt lgkmcnt(0)
    v_mfma_f32_16x16x16_bf16 v[64:67], v[92:93], v[20:21], 0
    v_mfma_f32_16x16x16_bf16 v[68:71], v[94:95], v[22:23], 0
    v_add_f32 v24, v24, v32
    v_add_f32 v40, v40, v48
    v_add_f32 v25, v25, v33
    v_add_f32 v41, v41, v49
    v_add_f32 v26, v26, v34
    v_add_f32 v42, v42, v50
    v_add_f32 v27, v27, v35
    v_add_f32 v43, v43, v51
    v_add_f32 v28, v28, v36
    v_add_f32 v44, v44, v52
    v_add_f32 v29, v29, v37
    v_add_f32 v45, v45, v53
    v_add_f32 v30, v30, v38
    v_add_f32 v46, v46, v54
    v_add_f32 v31, v31, v39
    v_add_f32 v47, v47, v55
    v_add_f32 v24, v24, v40
    v_add_f32 v25, v25, v41
    v_add_f32 v26, v26, v42
    v_add_f32 v27, v27, v43
    v_add_f32 v28, v28, v44
    v_add_f32 v29, v29, v45
    v_add_f32 v30, v30, v46
    v_add_f32 v31, v31, v47
    v_cvt_pk_bf16_f32 v32, v24, v25
    v_cvt_pk_bf16_f32 v33, v26, v27
    v_cvt_pk_bf16_f32 v34, v28, v29
    v_cvt_pk_bf16_f32 v35, v30, v31
    v_mfma_f32_16x16x16_bf16 v[56:59], v[32:33], v[20:21], 0
    s_nop 0
    v_mfma_f32_16x16x16_bf16 v[60:63], v[34:35], v[22:23], 0
    v_add_f32 v88, 0x358637bd, v64
    v_rcp_f32 v88, v88
    v_add_f32 v89, 0x358637bd, v68
    v_rcp_f32 v89, v89
    s_nop 1
    v_mul_f32 v56, v56, v88
    v_mul_f32 v57, v57, v88
    v_mul_f32 v58, v58, v88
    v_mul_f32 v59, v59, v88
    v_cvt_pk_bf16_f32 v96, v56, v57
    v_cvt_pk_bf16_f32 v97, v58, v59
    v_mul_f32 v60, v60, v89
    v_mul_f32 v61, v61, v89
    v_mul_f32 v62, v62, v89
    v_mul_f32 v63, v63, v89
    v_cvt_pk_bf16_f32 v98, v60, v61
    v_cvt_pk_bf16_f32 v99, v62, v63
    buffer_store_dwordx4 v[96:99], v1, s[40:43], s49 offen sc1
    s_lshl_b32 s47, s44, 4
    s_add_u32 s47, s47, s45
    s_add_u32 s47, s47, 256
    s_lshl_b32 s47, s47, 7
    s_lshl_b32 s48, s46, 3
    s_add_u32 s47, s47, s48
    v_mov_b32 v14, s59
    v_not_b32 v15, s59
    s_mov_b64 s[90:91], exec
    s_mov_b64 exec, 1
    s_waitcnt vmcnt(0)
    buffer_store_dwordx2 v[14:15], v7, s[40:43], s47 offen sc1
    s_mov_b64 exec, s[90:91]
    s_barrier
    s_mul_i32 s51, s46, 8192
    s_lshl_b32 s50, s7, 16
    s_add_u32 s50, s50, 15204352
    s_add_u32 s50, s50, s51
    s_add_u32 s51, s51, 0
    s_mov_b32 m0, s51
    s_nop 0
    buffer_load_dwordx4 v1, s[40:43], s50 offen offset:0 sc1 lds
    buffer_load_dwordx4 v1, s[40:43], s50 offen offset:1024 sc1 lds
    buffer_load_dwordx4 v1, s[40:43], s50 offen offset:2048 sc1 lds
    buffer_load_dwordx4 v1, s[40:43], s50 offen offset:3072 sc1 lds
    s_add_u32 s50, s50, 4096
    s_add_u32 s51, s51, 4096
    s_mov_b32 m0, s51
    s_nop 0
    buffer_load_dwordx4 v1, s[40:43], s50 offen offset:0 sc1 lds
    buffer_load_dwordx4 v1, s[40:43], s50 offen offset:1024 sc1 lds
    buffer_load_dwordx4 v1, s[40:43], s50 offen offset:2048 sc1 lds
    buffer_load_dwordx4 v1, s[40:43], s50 offen offset:3072 sc1 lds
    s_lshl_b32 s49, s53, 4
    s_lshl_b32 s48, s54, 3
    s_add_u32 s49, s49, s48
    s_lshl_b32 s49, s49, 10
    s_add_u32 s49, s49, 2097152
    s_lshl_b32 s48, s54, 15
    v_add_u32 v19, s48, v1
    s_barrier
    s_mul_i32 s51, s46, 8192
    s_mul_i32 s50, s45, 98304
    s_add_u32 s50, s50, 13631488
    s_add_u32 s50, s50, s51
    s_add_u32 s51, s51, 81920
    s_mov_b32 m0, s51
    s_nop 0
    buffer_load_dwordx4 v1, s[40:43], s50 offen offset:0 sc1 lds
    buffer_load_dwordx4 v1, s[40:43], s50 offen offset:1024 sc1 lds
    buffer_load_dwordx4 v1, s[40:43], s50 offen offset:2048 sc1 lds
    buffer_load_dwordx4 v1, s[40:43], s50 offen offset:3072 sc1 lds
    s_add_u32 s50, s50, 4096
    s_add_u32 s51, s51, 4096
    s_mov_b32 m0, s51
    s_nop 0
    buffer_load_dwordx4 v1, s[40:43], s50 offen offset:0 sc1 lds
    buffer_load_dwordx4 v1, s[40:43], s50 offen offset:1024 sc1 lds
    buffer_load_dwordx4 v1, s[40:43], s50 offen offset:2048 sc1 lds
    buffer_load_dwordx4 v1, s[40:43], s50 offen offset:3072 sc1 lds
    s_waitcnt vmcnt(8)
    s_cmp_lg_u32 s46, 0
    s_cbranch_scc1 L_pskip_15
    v_lshrrev_b32 v86, 2, v80
    v_lshlrev_b32 v86, 7, v86
    v_lshl_add_u32 v86, v83, 4, v86
    s_add_u32 s47, s44, 16
    s_lshl_b32 s47, s47, 11
    s_mov_b32 s57, 0
    s_not_b32 s48, s59
L_poll_16:
    buffer_load_dwordx4 v[88:91], v86, s[40:43], s47 offen sc1
    s_add_u32 s57, s57, 1
    s_waitcnt vmcnt(0)
    v_xor_b32 v88, s59, v88
    v_xor_b32 v89, s48, v89
    v_xor_b32 v90, s59, v90
    v_xor_b32 v91, s48, v91
    v_or_b32 v88, v88, v89
    v_or_b32 v90, v90, v91
    v_or_b32 v88, v88, v90
    v_cmp_eq_u32 vcc, 0, v88
    s_cmp_gt_u32 s57, 200000
    s_cbranch_scc1 L_pskip_15
    s_cmp_eq_u64 vcc, exec
    s_cbranch_scc0 L_poll_16
L_pskip_15:
    s_barrier
    buffer_load_dwordx4 v[104:107], v1, s[40:43], s49 offen offset:0 sc1
    buffer_load_dwordx4 v[108:111], v1, s[40:43], s49 offen offset:1024 sc1
    buffer_load_dwordx4 v[112:115], v1, s[40:43], s49 offen offset:2048 sc1
    buffer_load_dwordx4 v[116:119], v1, s[40:43], s49 offen offset:3072 sc1
    s_add_u32 s49, s49, 4096
    buffer_load_dwordx4 v[120:123], v1, s[40:43], s49 offen offset:0 sc1
    buffer_load_dwordx4 v[124:127], v1, s[40:43], s49 offen offset:1024 sc1
    buffer_load_dwordx4 v[128:131], v1, s[40:43], s49 offen offset:2048 sc1
    buffer_load_dwordx4 v[132:135], v1, s[40:43], s49 offen offset:3072 sc1
    s_setprio 2
    ds_read_b128 v[24:27], v19 offset:0
    ds_read_b128 v[28:31], v19 offset:1024
    ds_read_b128 v[32:35], v19 offset:2048
    ds_read_b128 v[36:39], v19 offset:3072
    ds_read_b128 v[40:43], v19 offset:4096
    ds_read_b128 v[44:47], v19 offset:5120
    s_waitcnt vmcnt(7)
    s_waitcnt lgkmcnt(5)
    v_mfma_f32_16x16x32_bf16 v[56:59], v[24:27], v[104:107], 0
    ds_read_b128 v[48:51], v19 offset:6144
    s_waitcnt lgkmcnt(5)
    v_mfma_f32_16x16x32_bf16 v[60:63], v[28:31], v[104:107], 0
    ds_read_b128 v[52:55], v19 offset:7168
    s_waitcnt lgkmcnt(5)
    v_mfma_f32_16x16x32_bf16 v[64:67], v[32:35], v[104:107], 0
    ds_read_b128 v[24:27], v19 offset:8192
    s_waitcnt lgkmcnt(5)
    v_mfma_f32_16x16x32_bf16 v[68:71], v[36:39], v[104:107], 0
    ds_read_b128 v[28:31], v19 offset:9216
    s_waitcnt vmcnt(6)
    s_waitcnt lgkmcnt(5)
    v_mfma_f32_16x16x32_bf16 v[56:59], v[40:43], v[108:111], v[56:59]
    ds_read_b128 v[32:35], v19 offset:10240
    s_waitcnt lgkmcnt(5)
    v_mfma_f32_16x16x32_bf16 v[60:63], v[44:47], v[108:111], v[60:63]
    ds_read_b128 v[36:39], v19 offset:11264
    s_waitcnt lgkmcnt(5)
    v_mfma_f32_16x16x32_bf16 v[64:67], v[48:51], v[108:111], v[64:67]
    ds_read_b128 v[40:43], v19 offset:12288
    s_waitcnt lgkmcnt(5)
    v_mfma_f32_16x16x32_bf16 v[68:71], v[52:55], v[108:111], v[68:71]
    ds_read_b128 v[44:47], v19 offset:13312
    s_waitcnt vmcnt(5)
    s_waitcnt lgkmcnt(5)
    v_mfma_f32_16x16x32_bf16 v[56:59], v[24:27], v[112:115], v[56:59]
    ds_read_b128 v[48:51], v19 offset:14336
    s_waitcnt lgkmcnt(5)
    v_mfma_f32_16x16x32_bf16 v[60:63], v[28:31], v[112:115], v[60:63]
    ds_read_b128 v[52:55], v19 offset:15360
    s_waitcnt lgkmcnt(5)
    v_mfma_f32_16x16x32_bf16 v[64:67], v[32:35], v[112:115], v[64:67]
    ds_read_b128 v[24:27], v19 offset:16384
    s_waitcnt lgkmcnt(5)
    v_mfma_f32_16x16x32_bf16 v[68:71], v[36:39], v[112:115], v[68:71]
    ds_read_b128 v[28:31], v19 offset:17408
    s_waitcnt vmcnt(4)
    s_waitcnt lgkmcnt(5)
    v_mfma_f32_16x16x32_bf16 v[56:59], v[40:43], v[116:119], v[56:59]
    ds_read_b128 v[32:35], v19 offset:18432
    s_waitcnt lgkmcnt(5)
    v_mfma_f32_16x16x32_bf16 v[60:63], v[44:47], v[116:119], v[60:63]
    ds_read_b128 v[36:39], v19 offset:19456
    s_waitcnt lgkmcnt(5)
    v_mfma_f32_16x16x32_bf16 v[64:67], v[48:51], v[116:119], v[64:67]
    ds_read_b128 v[40:43], v19 offset:20480
    s_waitcnt lgkmcnt(5)
    v_mfma_f32_16x16x32_bf16 v[68:71], v[52:55], v[116:119], v[68:71]
    ds_read_b128 v[44:47], v19 offset:21504
    s_waitcnt vmcnt(3)
    s_waitcnt lgkmcnt(5)
    v_mfma_f32_16x16x32_bf16 v[56:59], v[24:27], v[120:123], v[56:59]
    ds_read_b128 v[48:51], v19 offset:22528
    s_waitcnt lgkmcnt(5)
    v_mfma_f32_16x16x32_bf16 v[60:63], v[28:31], v[120:123], v[60:63]
    ds_read_b128 v[52:55], v19 offset:23552
    s_waitcnt lgkmcnt(5)
    v_mfma_f32_16x16x32_bf16 v[64:67], v[32:35], v[120:123], v[64:67]
    ds_read_b128 v[24:27], v19 offset:24576
    s_waitcnt lgkmcnt(5)
    v_mfma_f32_16x16x32_bf16 v[68:71], v[36:39], v[120:123], v[68:71]
    ds_read_b128 v[28:31], v19 offset:25600
    s_waitcnt vmcnt(2)
    s_waitcnt lgkmcnt(5)
    v_mfma_f32_16x16x32_bf16 v[56:59], v[40:43], v[124:127], v[56:59]
    ds_read_b128 v[32:35], v19 offset:26624
    s_waitcnt lgkmcnt(5)
    v_mfma_f32_16x16x32_bf16 v[60:63], v[44:47], v[124:127], v[60:63]
    ds_read_b128 v[36:39], v19 offset:27648
    s_waitcnt lgkmcnt(5)
    v_mfma_f32_16x16x32_bf16 v[64:67], v[48:51], v[124:127], v[64:67]
    ds_read_b128 v[40:43], v19 offset:28672
    s_waitcnt lgkmcnt(5)
    v_mfma_f32_16x16x32_bf16 v[68:71], v[52:55], v[124:127], v[68:71]
    ds_read_b128 v[44:47], v19 offset:29696
    s_waitcnt vmcnt(1)
    s_waitcnt lgkmcnt(5)
    v_mfma_f32_16x16x32_bf16 v[56:59], v[24:27], v[128:131], v[56:59]
    ds_read_b128 v[48:51], v19 offset:30720
    s_waitcnt lgkmcnt(5)
    v_mfma_f32_16x16x32_bf16 v[60:63], v[28:31], v[128:131], v[60:63]
    ds_read_b128 v[52:55], v19 offset:31744
    s_waitcnt lgkmcnt(5)
    v_mfma_f32_16x16x32_bf16 v[64:67], v[32:35], v[128:131], v[64:67]
    s_waitcnt lgkmcnt(4)
    v_mfma_f32_16x16x32_bf16 v[68:71], v[36:39], v[128:131], v[68:71]
    s_waitcnt vmcnt(0)
    s_waitcnt lgkmcnt(3)
    v_mfma_f32_16x16x32_bf16 v[56:59], v[40:43], v[132:135], v[56:59]
    s_waitcnt lgkmcnt(2)
    v_mfma_f32_16x16x32_bf16 v[60:63], v[44:47], v[132:135], v[60:63]
    s_waitcnt lgkmcnt(1)
    v_mfma_f32_16x16x32_bf16 v[64:67], v[48:51], v[132:135], v[64:67]
    s_waitcnt lgkmcnt(0)
    v_mfma_f32_16x16x32_bf16 v[68:71], v[52:55], v[132:135], v[68:71]
    s_setprio 0
    s_lshl_b32 s47, s46, 11
    s_add_u32 s47, s47, 65536
    v_add_u32 v86, s47, v1
    s_xor_b32 s48, s46, 4
    s_lshl_b32 s48, s48, 11
    s_add_u32 s48, s48, 65536
    v_add_u32 v87, s48, v1
    s_nop 4
    s_cmp_eq_u32 s54, 0
    s_cbranch_scc0 L_ex0_17
    ds_write_b128 v86, v[64:67]
    ds_write_b128 v86, v[68:71] offset:1024
    v_mov_b32 v72, v56
    v_mov_b32 v73, v57
    v_mov_b32 v74, v58
    v_mov_b32 v75, v59
    v_mov_b32 v76, v60
    v_mov_b32 v77, v61
    v_mov_b32 v78, v62
    v_mov_b32 v79, v63
    s_branch L_ex1_18
L_ex0_17:
    ds_write_b128 v86, v[56:59]
    ds_write_b128 v86, v[60:63] offset:1024
    v_mov_b32 v72, v64
    v_mov_b32 v73, v65
    v_mov_b32 v74, v66
    v_mov_b32 v75, v67
    v_mov_b32 v76, v68
    v_mov_b32 v77, v69
    v_mov_b32 v78, v70
    v_mov_b32 v79, v71
L_ex1_18:
    s_waitcnt lgkmcnt(0)
    s_barrier
    ds_read_b128 v[56:59], v87
    ds_read_b128 v[60:63], v87 offset:1024
    s_waitcnt lgkmcnt(0)
    v_add_f32 v72, v72, v56
    v_add_f32 v73, v73, v57
    v_add_f32 v74, v74, v58
    v_add_f32 v75, v75, v59
    v_add_f32 v76, v76, v60
    v_add_f32 v77, v77, v61
    v_add_f32 v78, v78, v62
    v_add_f32 v79, v79, v63
    v_lshlrev_b32 v88, 16, v136
    v_and_b32 v89, 0xffff0000, v136
    v_add_f32 v88, v88, v72
    v_add_f32 v89, v89, v73
    v_cvt_pk_bf16_f32 v20, v88, v89
    v_lshlrev_b32 v90, 16, v137
    v_and_b32 v91, 0xffff0000, v137
    v_add_f32 v90, v90, v74
    v_add_f32 v91, v91, v75
    v_cvt_pk_bf16_f32 v21, v90, v91
    v_lshlrev_b32 v88, 16, v138
    v_and_b32 v89, 0xffff0000, v138
    v_add_f32 v88, v88, v76
    v_add_f32 v89, v89, v77
    v_cvt_pk_bf16_f32 v22, v88, v89
    v_lshlrev_b32 v90, 16, v139
    v_and_b32 v91, 0xffff0000, v139
    v_add_f32 v90, v90, v78
    v_add_f32 v91, v91, v79
    v_cvt_pk_bf16_f32 v23, v90, v91
    s_lshr_b32 s48, s52, 6
    s_add_u32 s48, s48, s54
    s_lshl_b32 s49, s53, 4
    s_add_u32 s49, s49, s48
    s_lshl_b32 s49, s49, 10
    s_add_u32 s49, s49, 4194304
    buffer_store_dwordx4 v[20:23], v1, s[40:43], s49 offen sc1
    v_mov_b32 v88, 0
    v_mov_b32 v89, 0
    v_dot2c_f32_bf16 v88, s62, v20
    v_dot2c_f32_bf16 v89, v20, v20
    v_dot2c_f32_bf16 v88, s62, v21
    v_dot2c_f32_bf16 v89, v21, v21
    v_dot2c_f32_bf16 v88, s62, v22
    v_dot2c_f32_bf16 v89, v22, v22
    v_dot2c_f32_bf16 v88, s62, v23
    v_dot2c_f32_bf16 v89, v23, v23
    s_nop 1
    v_mov_b32 v86, v88
    v_mov_b32 v87, v89
    s_nop 0
    v_permlane32_swap_b32 v88, v86
    v_permlane32_swap_b32 v89, v87
    v_add_f32 v88, v88, v86
    v_add_f32 v89, v89, v87
    v_mov_b32 v86, v88
    v_mov_b32 v87, v89
    s_nop 0
    v_permlane16_swap_b32 v88, v86
    v_permlane16_swap_b32 v89, v87
    v_add_f32 v88, v88, v86
    v_add_f32 v89, v89, v87
    v_lshlrev_b32 v86, 3, v81
    s_lshl_b32 s49, s53, 11
    s_lshl_b32 s48, s48, 7
    s_add_u32 s49, s49, s48
    s_add_u32 s49, s49, 12582912
    s_mov_b64 s[90:91], exec
    s_mov_b64 exec, 0xffff
    buffer_store_dwordx2 v[88:89], v86, s[40:43], s49 offen sc1
    s_mov_b64 exec, s[90:91]
    s_lshl_b32 s47, s44, 4
    s_add_u32 s47, s47, s45
    s_add_u32 s47, s47, 512
    s_lshl_b32 s47, s47, 7
    s_lshl_b32 s48, s46, 3
    s_add_u32 s47, s47, s48
    v_mov_b32 v14, s59
    v_not_b32 v15, s59
    s_mov_b64 s[90:91], exec
    s_mov_b64 exec, 1
    s_waitcnt vmcnt(0)
    buffer_store_dwordx2 v[14:15], v7, s[40:43], s47 offen sc1
    s_mov_b64 exec, s[90:91]
    s_barrier
    s_mul_i32 s51, s46, 4096
    s_mul_i32 s50, s45, 98304
    s_add_u32 s50, s50, 13697024
    s_add_u32 s50, s50, s51
    s_add_u32 s51, s51, 0
    s_mov_b32 m0, s51
    s_nop 0
    buffer_load_dwordx4 v1, s[40:43], s50 offen offset:0 sc1 lds
    buffer_load_dwordx4 v1, s[40:43], s50 offen offset:1024 sc1 lds
    buffer_load_dwordx4 v1, s[40:43], s50 offen offset:2048 sc1 lds
    buffer_load_dwordx4 v1, s[40:43], s50 offen offset:3072 sc1 lds
    s_cmp_lt_u32 s46, 1
    s_cbranch_scc1 L_nocs_19
    s_cmp_ge_u32 s46, 5
    s_cbranch_scc1 L_nocs_19
    s_add_u32 s48, s46, 4294967295
    s_lshl_b32 s47, s48, 14
    s_add_u32 s47, s47, 81920
    v_add_u32 v86, s47, v1
    v_mov_b32 v88, s62
    v_mov_b32 v89, s62
    v_mov_b32 v90, s62
    v_mov_b32 v91, s62
    ds_read_b128 v[24:27], v86 offset:0
    ds_read_b128 v[28:31], v86 offset:1024
    ds_read_b128 v[32:35], v86 offset:2048
    ds_read_b128 v[36:39], v86 offset:3072
    ds_read_b128 v[40:43], v86 offset:4096
    ds_read_b128 v[44:47], v86 offset:5120
    ds_read_b128 v[48:51], v86 offset:6144
    ds_read_b128 v[52:55], v86 offset:7168
    s_waitcnt lgkmcnt(7)
    v_mfma_f32_16x16x32_bf16 v[92:95], v[88:91], v[24:27], 0
    ds_read_b128 v[24:27], v86 offset:8192
    s_waitcnt lgkmcnt(7)
    v_mfma_f32_16x16x32_bf16 v[92:95], v[88:91], v[28:31], v[92:95]
    ds_read_b128 v[28:31], v86 offset:9216
    s_waitcnt lgkmcnt(7)
    v_mfma_f32_16x16x32_bf16 v[92:95], v[88:91], v[32:35], v[92:95]
    ds_read_b128 v[32:35], v86 offset:10240
    s_waitcnt lgkmcnt(7)
    v_mfma_f32_16x16x32_bf16 v[92:95], v[88:91], v[36:39], v[92:95]
    ds_read_b128 v[36:39], v86 offset:11264
    s_waitcnt lgkmcnt(7)
    v_mfma_f32_16x16x32_bf16 v[92:95], v[88:91], v[40:43], v[92:95]
    ds_read_b128 v[40:43], v86 offset:12288
    s_waitcnt lgkmcnt(7)
    v_mfma_f32_16x16x32_bf16 v[92:95], v[88:91], v[44:47], v[92:95]
    ds_read_b128 v[44:47], v86 offset:13312
    s_waitcnt lgkmcnt(7)
    v_mfma_f32_16x16x32_bf16 v[92:95], v[88:91], v[48:51], v[92:95]
    ds_read_b128 v[48:51], v86 offset:14336
    s_waitcnt lgkmcnt(7)
    v_mfma_f32_16x16x32_bf16 v[92:95], v[88:91], v[52:55], v[92:95]
    ds_read_b128 v[52:55], v86 offset:15360
    s_waitcnt lgkmcnt(7)
    v_mfma_f32_16x16x32_bf16 v[92:95], v[88:91], v[24:27], v[92:95]
    s_waitcnt lgkmcnt(6)
    v_mfma_f32_16x16x32_bf16 v[92:95], v[88:91], v[28:31], v[92:95]
    s_waitcnt lgkmcnt(5)
    v_mfma_f32_16x16x32_bf16 v[92:95], v[88:91], v[32:35], v[92:95]
    s_waitcnt lgkmcnt(4)
    v_mfma_f32_16x16x32_bf16 v[92:95], v[88:91], v[36:39], v[92:95]
    s_waitcnt lgkmcnt(3)
    v_mfma_f32_16x16x32_bf16 v[92:95], v[88:91], v[40:43], v[92:95]
    s_waitcnt lgkmcnt(2)
    v_mfma_f32_16x16x32_bf16 v[92:95], v[88:91], v[44:47], v[92:95]
    s_waitcnt lgkmcnt(1)
    v_mfma_f32_16x16x32_bf16 v[92:95], v[88:91], v[48:51], v[92:95]
    s_waitcnt lgkmcnt(0)
    v_mfma_f32_16x16x32_bf16 v[92:95], v[88:91], v[52:55], v[92:95]
    v_lshlrev_b32 v86, 2, v81
    s_lshl_b32 s47, s48, 6
    s_add_u32 s47, s47, 159744
    v_add_u32 v86, s47, v86
    s_nop 3
    ds_write_b32 v86, v92
    s_waitcnt lgkmcnt(0)
L_nocs_19:
    v_lshlrev_b32 v216, 16, v240
    v_and_b32 v217, 0xffff0000, v240
    v_lshlrev_b32 v218, 16, v241
    v_and_b32 v219, 0xffff0000, v241
    v_lshlrev_b32 v220, 16, v242
    v_and_b32 v221, 0xffff0000, v242
    v_lshlrev_b32 v222, 16, v243
    v_and_b32 v223, 0xffff0000, v243
    v_lshlrev_b32 v224, 16, v244
    v_and_b32 v225, 0xffff0000, v244
    v_lshlrev_b32 v226, 16, v245
    v_and_b32 v227, 0xffff0000, v245
    v_lshlrev_b32 v228, 16, v246
    v_and_b32 v229, 0xffff0000, v246
    v_lshlrev_b32 v230, 16, v247
    v_and_b32 v231, 0xffff0000, v247
    v_lshlrev_b32 v232, 16, v248
    v_and_b32 v233, 0xffff0000, v248
    v_lshlrev_b32 v234, 16, v249
    v_and_b32 v235, 0xffff0000, v249
    v_lshlrev_b32 v236, 16, v250
    v_and_b32 v237, 0xffff0000, v250
    v_lshlrev_b32 v238, 16, v251
    v_and_b32 v239, 0xffff0000, v251
    v_mul_f32 v216, 0x3fb8aa3b, v216
    v_mul_f32 v217, 0x3fb8aa3b, v217
    v_mul_f32 v218, 0x3fb8aa3b, v218
    v_mul_f32 v219, 0x3fb8aa3b, v219
    v_mul_f32 v220, 0x3fb8aa3b, v220
    v_mul_f32 v221, 0x3fb8aa3b, v221
    v_mul_f32 v222, 0x3fb8aa3b, v222
    v_mul_f32 v223, 0x3fb8aa3b, v223
    v_mul_f32 v224, 0x3fb8aa3b, v224
    v_mul_f32 v225, 0x3fb8aa3b, v225
    v_mul_f32 v226, 0x3fb8aa3b, v226
    v_mul_f32 v227, 0x3fb8aa3b, v227
    v_mul_f32 v228, 0x3fb8aa3b, v228
    v_mul_f32 v229, 0x3fb8aa3b, v229
    v_mul_f32 v230, 0x3fb8aa3b, v230
    v_mul_f32 v231, 0x3fb8aa3b, v231
    v_mul_f32 v232, 0x3fb8aa3b, v232
    v_mul_f32 v233, 0x3fb8aa3b, v233
    v_mul_f32 v234, 0x3fb8aa3b, v234
    v_mul_f32 v235, 0x3fb8aa3b, v235
    v_mul_f32 v236, 0x3fb8aa3b, v236
    v_mul_f32 v237, 0x3fb8aa3b, v237
    v_mul_f32 v238, 0x3fb8aa3b, v238
    v_mul_f32 v239, 0x3fb8aa3b, v239
    v_mov_b32 v252, 0x3f317218
    s_mov_b32 s93, 0xbfb17218
    s_lshl_b32 s49, s44, 3
    s_add_u32 s49, s49, s46
    s_lshl_b32 s63, s49, 11
    s_add_u32 s63, s63, 12582912
    s_lshl_b32 s49, s49, 14
    s_add_u32 s49, s49, 4194304
    v_lshlrev_b32 v19, 3, v81
    v_lshl_add_u32 v19, v82, 9, v19
    s_waitcnt vmcnt(0)
    s_barrier
    s_cmp_lt_u32 s46, 5
    s_cbranch_scc1 L_nocs_20
    s_cmp_ge_u32 s46, 7
    s_cbranch_scc1 L_nocs_20
    s_add_u32 s48, s46, 4294967295
    s_lshl_b32 s47, s48, 14
    s_add_u32 s47, s47, 4294901760
    v_add_u32 v86, s47, v1
    v_mov_b32 v88, s62
    v_mov_b32 v89, s62
    v_mov_b32 v90, s62
    v_mov_b32 v91, s62
    ds_read_b128 v[24:27], v86 offset:0
    ds_read_b128 v[28:31], v86 offset:1024
    ds_read_b128 v[32:35], v86 offset:2048
    ds_read_b128 v[36:39], v86 offset:3072
    ds_read_b128 v[40:43], v86 offset:4096
    ds_read_b128 v[44:47], v86 offset:5120
    ds_read_b128 v[48:51], v86 offset:6144
    ds_read_b128 v[52:55], v86 offset:7168
    s_waitcnt lgkmcnt(7)
    v_mfma_f32_16x16x32_bf16 v[92:95], v[88:91], v[24:27], 0
    ds_read_b128 v[24:27], v86 offset:8192
    s_waitcnt lgkmcnt(7)
    v_mfma_f32_16x16x32_bf16 v[92:95], v[88:91], v[28:31], v[92:95]
    ds_read_b128 v[28:31], v86 offset:9216
    s_waitcnt lgkmcnt(7)
    v_mfma_f32_16x16x32_bf16 v[92:95], v[88:91], v[32:35], v[92:95]
    ds_read_b128 v[32:35], v86 offset:10240
    s_waitcnt lgkmcnt(7)
    v_mfma_f32_16x16x32_bf16 v[92:95], v[88:91], v[36:39], v[92:95]
    ds_read_b128 v[36:39], v86 offset:11264
    s_waitcnt lgkmcnt(7)
    v_mfma_f32_16x16x32_bf16 v[92:95], v[88:91], v[40:43], v[92:95]
    ds_read_b128 v[40:43], v86 offset:12288
    s_waitcnt lgkmcnt(7)
    v_mfma_f32_16x16x32_bf16 v[92:95], v[88:91], v[44:47], v[92:95]
    ds_read_b128 v[44:47], v86 offset:13312
    s_waitcnt lgkmcnt(7)
    v_mfma_f32_16x16x32_bf16 v[92:95], v[88:91], v[48:51], v[92:95]
    ds_read_b128 v[48:51], v86 offset:14336
    s_waitcnt lgkmcnt(7)
    v_mfma_f32_16x16x32_bf16 v[92:95], v[88:91], v[52:55], v[92:95]
    ds_read_b128 v[52:55], v86 offset:15360
    s_waitcnt lgkmcnt(7)
    v_mfma_f32_16x16x32_bf16 v[92:95], v[88:91], v[24:27], v[92:95]
    s_waitcnt lgkmcnt(6)
    v_mfma_f32_16x16x32_bf16 v[92:95], v[88:91], v[28:31], v[92:95]
    s_waitcnt lgkmcnt(5)
    v_mfma_f32_16x16x32_bf16 v[92:95], v[88:91], v[32:35], v[92:95]
    s_waitcnt lgkmcnt(4)
    v_mfma_f32_16x16x32_bf16 v[92:95], v[88:91], v[36:39], v[92:95]
    s_waitcnt lgkmcnt(3)
    v_mfma_f32_16x16x32_bf16 v[92:95], v[88:91], v[40:43], v[92:95]
    s_waitcnt lgkmcnt(2)
    v_mfma_f32_16x16x32_bf16 v[92:95], v[88:91], v[44:47], v[92:95]
    s_waitcnt lgkmcnt(1)
    v_mfma_f32_16x16x32_bf16 v[92:95], v[88:91], v[48:51], v[92:95]
    s_waitcnt lgkmcnt(0)
    v_mfma_f32_16x16x32_bf16 v[92:95], v[88:91], v[52:55], v[92:95]
    v_lshlrev_b32 v86, 2, v81
    s_lshl_b32 s47, s48, 6
    s_add_u32 s47, s47, 159744
    v_add_u32 v86, s47, v86
    s_nop 3
    ds_write_b32 v86, v92
    s_waitcnt lgkmcnt(0)
L_nocs_20:
    s_lshl_b32 s51, s46, 1
    s_add_u32 s51, s51, 8
    s_add_u32 s50, s51, 16
    s_cmp_ge_u32 s46, 6
    s_cselect_b32 s51, s50, s51
    s_lshl_b32 s51, s51, 12
    s_mul_i32 s50, s7, 180224
    s_add_u32 s50, s50, s51
    s_add_u32 s50, s50, 15728640
    s_mov_b32 m0, s51
    s_nop 0
    buffer_load_dwordx4 v1, s[40:43], s50 offen offset:0 sc1 lds
    buffer_load_dwordx4 v1, s[40:43], s50 offen offset:1024 sc1 lds
    buffer_load_dwordx4 v1, s[40:43], s50 offen offset:2048 sc1 lds
    buffer_load_dwordx4 v1, s[40:43], s50 offen offset:3072 sc1 lds
    s_cmp_eq_u32 s46, 7
    s_cbranch_scc1 L_now2y
    s_add_u32 s50, s50, 4096
    s_add_u32 s51, s51, 4096
    s_mov_b32 m0, s51
    s_nop 0
    buffer_load_dwordx4 v1, s[40:43], s50 offen offset:0 sc1 lds
    buffer_load_dwordx4 v1, s[40:43], s50 offen offset:1024 sc1 lds
    buffer_load_dwordx4 v1, s[40:43], s50 offen offset:2048 sc1 lds
    buffer_load_dwordx4 v1, s[40:43], s50 offen offset:3072 sc1 lds
L_now2y:
    s_cmp_lg_u32 s46, 0
    s_cbranch_scc1 L_pskip_21
    v_lshrrev_b32 v86, 2, v80
    v_lshlrev_b32 v86, 7, v86
    v_lshl_add_u32 v86, v83, 4, v86
    s_add_u32 s47, s44, 32
    s_lshl_b32 s47, s47, 11
    s_mov_b32 s57, 0
    s_not_b32 s48, s59
L_poll_22:
    buffer_load_dwordx4 v[88:91], v86, s[40:43], s47 offen sc1
    s_add_u32 s57, s57, 1
    s_waitcnt vmcnt(0)
    v_xor_b32 v88, s59, v88
    v_xor_b32 v89, s48, v89
    v_xor_b32 v90, s59, v90
    v_xor_b32 v91, s48, v91
    v_or_b32 v88, v88, v89
    v_or_b32 v90, v90, v91
    v_or_b32 v88, v88, v90
    v_cmp_eq_u32 vcc, 0, v88
    s_cmp_gt_u32 s57, 200000
    s_cbranch_scc1 L_pskip_21
    s_cmp_eq_u64 vcc, exec
    s_cbranch_scc0 L_poll_22
L_pskip_21:
    s_barrier
    s_mov_b32 s58, s49
    v_add_u32 v253, 81920, v1
    buffer_load_dwordx4 v[104:107], v1, s[40:43], s58 offen offset:0 sc1
    buffer_load_dwordx4 v[108:111], v1, s[40:43], s58 offen offset:1024 sc1
    buffer_load_dwordx4 v[112:115], v1, s[40:43], s58 offen offset:2048 sc1
    buffer_load_dwordx4 v[116:119], v1, s[40:43], s58 offen offset:3072 sc1
    s_add_u32 s58, s58, 4096
    buffer_load_dwordx4 v[120:123], v1, s[40:43], s58 offen offset:0 sc1
    buffer_load_dwordx4 v[124:127], v1, s[40:43], s58 offen offset:1024 sc1
    buffer_load_dwordx4 v[128:131], v1, s[40:43], s58 offen offset:2048 sc1
    buffer_load_dwordx4 v[132:135], v1, s[40:43], s58 offen offset:3072 sc1
    v_mov_b32 v254, v19
    v_lshlrev_b32 v19, 4, v82
    v_add_u32 v19, 159744, v19
    s_setprio 2
    ds_read_b128 v[24:27], v253 offset:0
    ds_read_b128 v[28:31], v253 offset:16384
    ds_read_b128 v[32:35], v253 offset:32768
    ds_read_b128 v[36:39], v253 offset:49152
    ds_read_b128 v[40:43], v253 offset:1024
    ds_read_b128 v[44:47], v253 offset:17408
    s_waitcnt vmcnt(7)
    s_waitcnt lgkmcnt(5)
    v_mfma_f32_16x16x32_bf16 v[56:59], v[24:27], v[104:107], 0
    s_add_u32 s58, s58, 4096
    buffer_load_dwordx4 v[136:139], v1, s[40:43], s58 offen offset:0 sc1
    ds_read_b128 v[48:51], v253 offset:33792
    s_waitcnt lgkmcnt(5)
    v_mfma_f32_16x16x32_bf16 v[60:63], v[28:31], v[104:107], 0
    ds_read_b128 v[52:55], v253 offset:50176
    s_waitcnt lgkmcnt(5)
    v_mfma_f32_16x16x32_bf16 v[64:67], v[32:35], v[104:107], 0
    ds_read_b128 v[24:27], v253 offset:2048
    s_waitcnt lgkmcnt(5)
    v_mfma_f32_16x16x32_bf16 v[68:71], v[36:39], v[104:107], 0
    ds_read_b128 v[28:31], v253 offset:18432
    s_waitcnt vmcnt(7)
    s_waitcnt lgkmcnt(5)
    v_mfma_f32_16x16x32_bf16 v[56:59], v[40:43], v[108:111], v[56:59]
    buffer_load_dwordx4 v[140:143], v1, s[40:43], s58 offen offset:1024 sc1
    ds_read_b128 v[32:35], v253 offset:34816
    s_waitcnt lgkmcnt(5)
    v_mfma_f32_16x16x32_bf16 v[60:63], v[44:47], v[108:111], v[60:63]
    ds_read_b128 v[36:39], v253 offset:51200
    s_waitcnt lgkmcnt(5)
    v_mfma_f32_16x16x32_bf16 v[64:67], v[48:51], v[108:111], v[64:67]
    ds_read_b128 v[40:43], v253 offset:3072
    s_waitcnt lgkmcnt(5)
    v_mfma_f32_16x16x32_bf16 v[68:71], v[52:55], v[108:111], v[68:71]
    ds_read_b128 v[44:47], v253 offset:19456
    s_waitcnt vmcnt(7)
    s_waitcnt lgkmcnt(5)
    v_mfma_f32_16x16x32_bf16 v[56:59], v[24:27], v[112:115], v[56:59]
    buffer_load_dwordx4 v[144:147], v1, s[40:43], s58 offen offset:2048 sc1
    ds_read_b128 v[48:51], v253 offset:35840
    s_waitcnt lgkmcnt(5)
    v_mfma_f32_16x16x32_bf16 v[60:63], v[28:31], v[112:115], v[60:63]
    ds_read_b128 v[52:55], v253 offset:52224
    s_waitcnt lgkmcnt(5)
    v_mfma_f32_16x16x32_bf16 v[64:67], v[32:35], v[112:115], v[64:67]
    ds_read_b128 v[24:27], v253 offset:4096
    s_waitcnt lgkmcnt(5)
    v_mfma_f32_16x16x32_bf16 v[68:71], v[36:39], v[112:115], v[68:71]
    ds_read_b128 v[28:31], v253 offset:20480
    s_waitcnt vmcnt(7)
    s_waitcnt lgkmcnt(5)
    v_mfma_f32_16x16x32_bf16 v[56:59], v[40:43], v[116:119], v[56:59]
    buffer_load_dwordx4 v[148:151], v1, s[40:43], s58 offen offset:3072 sc1
    ds_read_b128 v[32:35], v253 offset:36864
    s_waitcnt lgkmcnt(5)
    v_mfma_f32_16x16x32_bf16 v[60:63], v[44:47], v[116:119], v[60:63]
    ds_read_b128 v[36:39], v253 offset:53248
    s_waitcnt lgkmcnt(5)
    v_mfma_f32_16x16x32_bf16 v[64:67], v[48:51], v[116:119], v[64:67]
    ds_read_b128 v[40:43], v253 offset:5120
    s_waitcnt lgkmcnt(5)
    v_mfma_f32_16x16x32_bf16 v[68:71], v[52:55], v[116:119], v[68:71]
    ds_read_b128 v[44:47], v253 offset:21504
    s_waitcnt vmcnt(7)
    s_waitcnt lgkmcnt(5)
    v_mfma_f32_16x16x32_bf16 v[56:59], v[24:27], v[120:123], v[56:59]
    s_add_u32 s58, s58, 4096
    buffer_load_dwordx4 v[152:155], v1, s[40:43], s58 offen offset:0 sc1
    ds_read_b128 v[48:51], v253 offset:37888
    s_waitcnt lgkmcnt(5)
    v_mfma_f32_16x16x32_bf16 v[60:63], v[28:31], v[120:123], v[60:63]
    ds_read_b128 v[52:55], v253 offset:54272
    s_waitcnt lgkmcnt(5)
    v_mfma_f32_16x16x32_bf16 v[64:67], v[32:35], v[120:123], v[64:67]
    ds_read_b128 v[24:27], v253 offset:6144
    s_waitcnt lgkmcnt(5)
    v_mfma_f32_16x16x32_bf16 v[68:71], v[36:39], v[120:123], v[68:71]
    ds_read_b128 v[28:31], v253 offset:22528
    s_waitcnt vmcnt(7)
    s_waitcnt lgkmcnt(5)
    v_mfma_f32_16x16x32_bf16 v[56:59], v[40:43], v[124:127], v[56:59]
    buffer_load_dwordx4 v[156:159], v1, s[40:43], s58 offen offset:1024 sc1
    ds_read_b128 v[32:35], v253 offset:38912
    s_waitcnt lgkmcnt(5)
    v_mfma_f32_16x16x32_bf16 v[60:63], v[44:47], v[124:127], v[60:63]
    ds_read_b128 v[36:39], v253 offset:55296
    s_waitcnt lgkmcnt(5)
    v_mfma_f32_16x16x32_bf16 v[64:67], v[48:51], v[124:127], v[64:67]
    ds_read_b128 v[40:43], v253 offset:7168
    s_waitcnt lgkmcnt(5)
    v_mfma_f32_16x16x32_bf16 v[68:71], v[52:55], v[124:127], v[68:71]
    ds_read_b128 v[44:47], v253 offset:23552
    s_waitcnt vmcnt(7)
    s_waitcnt lgkmcnt(5)
    v_mfma_f32_16x16x32_bf16 v[56:59], v[24:27], v[128:131], v[56:59]
    buffer_load_dwordx4 v[160:163], v1, s[40:43], s58 offen offset:2048 sc1
    ds_read_b128 v[48:51], v253 offset:39936
    s_waitcnt lgkmcnt(5)
    v_mfma_f32_16x16x32_bf16 v[60:63], v[28:31], v[128:131], v[60:63]
    ds_read_b128 v[52:55], v253 offset:56320
    s_waitcnt lgkmcnt(5)
    v_mfma_f32_16x16x32_bf16 v[64:67], v[32:35], v[128:131], v[64:67]
    ds_read_b128 v[24:27], v253 offset:8192
    s_waitcnt lgkmcnt(5)
    v_mfma_f32_16x16x32_bf16 v[68:71], v[36:39], v[128:131], v[68:71]
    ds_read_b128 v[28:31], v253 offset:24576
    s_waitcnt vmcnt(7)
    s_waitcnt lgkmcnt(5)
    v_mfma_f32_16x16x32_bf16 v[56:59], v[40:43], v[132:135], v[56:59]
    buffer_load_dwordx4 v[164:167], v1, s[40:43], s58 offen offset:3072 sc1
    ds_read_b128 v[32:35], v253 offset:40960
    s_waitcnt lgkmcnt(5)
    v_mfma_f32_16x16x32_bf16 v[60:63], v[44:47], v[132:135], v[60:63]
    ds_read_b128 v[36:39], v253 offset:57344
    s_waitcnt lgkmcnt(5)
    v_mfma_f32_16x16x32_bf16 v[64:67], v[48:51], v[132:135], v[64:67]
    ds_read_b128 v[40:43], v253 offset:9216
    s_waitcnt lgkmcnt(5)
    v_mfma_f32_16x16x32_bf16 v[68:71], v[52:55], v[132:135], v[68:71]
    ds_read_b128 v[44:47], v253 offset:25600
    s_waitcnt vmcnt(7)
    s_waitcnt lgkmcnt(5)
    v_mfma_f32_16x16x32_bf16 v[56:59], v[24:27], v[136:139], v[56:59]
    buffer_load_dwordx2 v[96:97], v254, s[40:43], s63 offen offset:0 sc1
    ds_read_b128 v[48:51], v253 offset:41984
    s_waitcnt lgkmcnt(5)
    v_mfma_f32_16x16x32_bf16 v[60:63], v[28:31], v[136:139], v[60:63]
    ds_read_b128 v[52:55], v253 offset:58368
    s_waitcnt lgkmcnt(5)
    v_mfma_f32_16x16x32_bf16 v[64:67], v[32:35], v[136:139], v[64:67]
    ds_read_b128 v[24:27], v253 offset:10240
    s_waitcnt lgkmcnt(5)
    v_mfma_f32_16x16x32_bf16 v[68:71], v[36:39], v[136:139], v[68:71]
    ds_read_b128 v[28:31], v253 offset:26624
    s_waitcnt vmcnt(7)
    s_waitcnt lgkmcnt(5)
    v_mfma_f32_16x16x32_bf16 v[56:59], v[40:43], v[140:143], v[56:59]
    buffer_load_dwordx2 v[98:99], v254, s[40:43], s63 offen offset:128 sc1
    ds_read_b128 v[32:35], v253 offset:43008
    s_waitcnt lgkmcnt(5)
    v_mfma_f32_16x16x32_bf16 v[60:63], v[44:47], v[140:143], v[60:63]
    ds_read_b128 v[36:39], v253 offset:59392
    s_waitcnt lgkmcnt(5)
    v_mfma_f32_16x16x32_bf16 v[64:67], v[48:51], v[140:143], v[64:67]
    ds_read_b128 v[40:43], v253 offset:11264
    s_waitcnt lgkmcnt(5)
    v_mfma_f32_16x16x32_bf16 v[68:71], v[52:55], v[140:143], v[68:71]
    ds_read_b128 v[44:47], v253 offset:27648
    s_waitcnt vmcnt(7)
    s_waitcnt lgkmcnt(5)
    v_mfma_f32_16x16x32_bf16 v[56:59], v[24:27], v[144:147], v[56:59]
    buffer_load_dwordx2 v[100:101], v254, s[40:43], s63 offen offset:256 sc1
    ds_read_b128 v[48:51], v253 offset:44032
    s_waitcnt lgkmcnt(5)
    v_mfma_f32_16x16x32_bf16 v[60:63], v[28:31], v[144:147], v[60:63]
    ds_read_b128 v[52:55], v253 offset:60416
    s_waitcnt lgkmcnt(5)
    v_mfma_f32_16x16x32_bf16 v[64:67], v[32:35], v[144:147], v[64:67]
    ds_read_b128 v[24:27], v253 offset:12288
    s_waitcnt lgkmcnt(5)
    v_mfma_f32_16x16x32_bf16 v[68:71], v[36:39], v[144:147], v[68:71]
    ds_read_b128 v[28:31], v253 offset:28672
    s_waitcnt vmcnt(7)
    s_waitcnt lgkmcnt(5)
    v_mfma_f32_16x16x32_bf16 v[56:59], v[40:43], v[148:151], v[56:59]
    buffer_load_dwordx2 v[102:103], v254, s[40:43], s63 offen offset:384 sc1
    ds_read_b128 v[32:35], v253 offset:45056
    s_waitcnt lgkmcnt(5)
    v_mfma_f32_16x16x32_bf16 v[60:63], v[44:47], v[148:151], v[60:63]
    ds_read_b128 v[36:39], v253 offset:61440
    s_waitcnt lgkmcnt(5)
    v_mfma_f32_16x16x32_bf16 v[64:67], v[48:51], v[148:151], v[64:67]
    ds_read_b128 v[40:43], v253 offset:13312
    s_waitcnt lgkmcnt(5)
    v_mfma_f32_16x16x32_bf16 v[68:71], v[52:55], v[148:151], v[68:71]
    ds_read_b128 v[44:47], v253 offset:29696
    s_waitcnt vmcnt(7)
    s_waitcnt lgkmcnt(5)
    v_mfma_f32_16x16x32_bf16 v[56:59], v[24:27], v[152:155], v[56:59]
    s_lshl_b32 s51, s46, 12
    s_mul_i32 s50, s7, 180224
    s_add_u32 s50, s50, s51
    s_add_u32 s50, s50, 15728640
    buffer_load_dwordx4 v[168:171], v1, s[40:43], s50 offen offset:0 sc1
    ds_read_b128 v[48:51], v253 offset:46080
    s_waitcnt lgkmcnt(5)
    v_mfma_f32_16x16x32_bf16 v[60:63], v[28:31], v[152:155], v[60:63]
    ds_read_b128 v[52:55], v253 offset:62464
    s_waitcnt lgkmcnt(5)
    v_mfma_f32_16x16x32_bf16 v[64:67], v[32:35], v[152:155], v[64:67]
    ds_read_b128 v[24:27], v253 offset:14336
    s_waitcnt lgkmcnt(5)
    v_mfma_f32_16x16x32_bf16 v[68:71], v[36:39], v[152:155], v[68:71]
    ds_read_b128 v[28:31], v253 offset:30720
    s_waitcnt vmcnt(7)
    s_waitcnt lgkmcnt(5)
    v_mfma_f32_16x16x32_bf16 v[56:59], v[40:43], v[156:159], v[56:59]
    buffer_load_dwordx4 v[172:175], v1, s[40:43], s50 offen offset:1024 sc1
    ds_read_b128 v[32:35], v253 offset:47104
    s_waitcnt lgkmcnt(5)
    v_mfma_f32_16x16x32_bf16 v[60:63], v[44:47], v[156:159], v[60:63]
    ds_read_b128 v[36:39], v253 offset:63488
    s_waitcnt lgkmcnt(5)
    v_mfma_f32_16x16x32_bf16 v[64:67], v[48:51], v[156:159], v[64:67]
    ds_read_b128 v[40:43], v253 offset:15360
    s_waitcnt lgkmcnt(5)
    v_mfma_f32_16x16x32_bf16 v[68:71], v[52:55], v[156:159], v[68:71]
    ds_read_b128 v[44:47], v253 offset:31744
    s_waitcnt vmcnt(7)
    s_waitcnt lgkmcnt(5)
    v_mfma_f32_16x16x32_bf16 v[56:59], v[24:27], v[160:163], v[56:59]
    buffer_load_dwordx4 v[176:179], v1, s[40:43], s50 offen offset:2048 sc1
    ds_read_b128 v[48:51], v253 offset:48128
    s_waitcnt lgkmcnt(5)
    v_mfma_f32_16x16x32_bf16 v[60:63], v[28:31], v[160:163], v[60:63]
    ds_read_b128 v[52:55], v253 offset:64512
    s_waitcnt lgkmcnt(5)
    v_mfma_f32_16x16x32_bf16 v[64:67], v[32:35], v[160:163], v[64:67]
    s_waitcnt lgkmcnt(4)
    v_mfma_f32_16x16x32_bf16 v[68:71], v[36:39], v[160:163], v[68:71]
    s_waitcnt vmcnt(7)
    s_waitcnt lgkmcnt(3)
    v_mfma_f32_16x16x32_bf16 v[56:59], v[40:43], v[164:167], v[56:59]
    buffer_load_dwordx4 v[180:183], v1, s[40:43], s50 offen offset:3072 sc1
    s_waitcnt lgkmcnt(2)
    v_mfma_f32_16x16x32_bf16 v[60:63], v[44:47], v[164:167], v[60:63]
    s_waitcnt lgkmcnt(1)
    v_mfma_f32_16x16x32_bf16 v[64:67], v[48:51], v[164:167], v[64:67]
    s_waitcnt lgkmcnt(0)
    v_mfma_f32_16x16x32_bf16 v[68:71], v[52:55], v[164:167], v[68:71]
    s_setprio 0
    s_waitcnt vmcnt(4)
    v_add_f32 v17, v96, v98
    v_add_f32 v18, v97, v99
    v_add_f32 v100, v100, v102
    v_add_f32 v101, v101, v103
    v_add_f32 v17, v17, v100
    v_add_f32 v18, v18, v101
    ds_read_b128 v[96:99], v19 offset:0
    ds_read_b128 v[100:103], v19 offset:64
    v_mov_b32 v86, v17
    v_mov_b32 v87, v18
    s_nop 0
    v_permlane32_swap_b32 v17, v86
    v_permlane32_swap_b32 v18, v87
    v_add_f32 v17, v17, v86
    v_add_f32 v18, v18, v87
    v_mov_b32 v86, v17
    v_mov_b32 v87, v18
    s_nop 0
    v_permlane16_swap_b32 v17, v86
    v_permlane16_swap_b32 v18, v87
    v_add_f32 v17, v17, v86
    v_add_f32 v18, v18, v87
    v_mul_f32 v17, 0x3b000000, v17
    v_mul_f32 v18, 0x3b000000, v18
    v_fma_f32 v18, -v17, v17, v18
    v_max_f32 v18, 0, v18
    v_add_f32 v18, 0x3727c5ac, v18
    v_rsq_f32 v18, v18
    s_nop 0
    v_mul_f32 v17, v17, v18
    v_mul_f32 v17, 0x3fb8aa3b, v17
    v_mul_f32 v18, 0x3fb8aa3b, v18
    s_lshl_b32 s63, s44, 3
    s_add_u32 s63, s63, s46
    s_mul_i32 s63, s63, 43
    s_lshl_b32 s51, s46, 13
    s_add_u32 s51, s51, 81920
    s_mul_i32 s50, s7, 180224
    s_add_u32 s50, s50, s51
    s_add_u32 s50, s50, 15728640
    buffer_load_dwordx4 v[184:187], v1, s[40:43], s50 offen offset:0 sc1
    buffer_load_dwordx4 v[188:191], v1, s[40:43], s50 offen offset:1024 sc1
    buffer_load_dwordx4 v[192:195], v1, s[40:43], s50 offen offset:2048 sc1
    buffer_load_dwordx4 v[196:199], v1, s[40:43], s50 offen offset:3072 sc1
    s_lshl_b32 s51, s46, 13
    s_add_u32 s51, s51, 86016
    s_mul_i32 s50, s7, 180224
    s_add_u32 s50, s50, s51
    s_add_u32 s50, s50, 15728640
    buffer_load_dwordx4 v[200:203], v1, s[40:43], s50 offen offset:0 sc1
    buffer_load_dwordx4 v[204:207], v1, s[40:43], s50 offen offset:1024 sc1
    buffer_load_dwordx4 v[208:211], v1, s[40:43], s50 offen offset:2048 sc1
    buffer_load_dwordx4 v[212:215], v1, s[40:43], s50 offen offset:3072 sc1
    s_setprio 2
    ds_read_b128 v[24:27], v1 offset:0
    ds_read_b128 v[28:31], v1 offset:16384
    ds_read_b128 v[32:35], v1 offset:1024
    ds_read_b128 v[36:39], v1 offset:17408
    ds_read_b128 v[40:43], v1 offset:2048
    ds_read_b128 v[44:47], v1 offset:18432
    s_waitcnt lgkmcnt(5)
    v_mfma_f32_16x16x32_bf16 v[72:75], v[24:27], v[104:107], 0
    ds_read_b128 v[48:51], v1 offset:3072
    s_waitcnt lgkmcnt(5)
    v_mfma_f32_16x16x32_bf16 v[76:79], v[28:31], v[104:107], 0
    ds_read_b128 v[52:55], v1 offset:19456
    s_waitcnt lgkmcnt(5)
    v_mfma_f32_16x16x32_bf16 v[72:75], v[32:35], v[108:111], v[72:75]
    ds_read_b128 v[24:27], v1 offset:4096
    s_waitcnt lgkmcnt(5)
    v_mfma_f32_16x16x32_bf16 v[76:79], v[36:39], v[108:111], v[76:79]
    v_fma_f32 v88, -v17, v96, v216
    v_fma_f32 v91, -v17, v97, v217
    ds_read_b128 v[28:31], v1 offset:20480
    s_waitcnt lgkmcnt(5)
    v_mfma_f32_16x16x32_bf16 v[72:75], v[40:43], v[112:115], v[72:75]
    v_fma_f32 v56, v56, v18, v88
    v_fma_f32 v57, v57, v18, v91
    ds_read_b128 v[32:35], v1 offset:5120
    s_waitcnt lgkmcnt(5)
    v_mfma_f32_16x16x32_bf16 v[76:79], v[44:47], v[112:115], v[76:79]
    v_exp_f32 v89, v56
    v_exp_f32 v92, v57
    ds_read_b128 v[36:39], v1 offset:21504
    s_waitcnt lgkmcnt(5)
    v_mfma_f32_16x16x32_bf16 v[72:75], v[48:51], v[116:119], v[72:75]
    v_add_f32 v90, 2.0, v89
    v_add_f32 v93, 2.0, v92
    ds_read_b128 v[40:43], v1 offset:6144
    s_waitcnt lgkmcnt(5)
    v_mfma_f32_16x16x32_bf16 v[76:79], v[52:55], v[116:119], v[76:79]
    v_fma_f32 v89, v89, v90, 2.0
    v_fma_f32 v92, v92, v93, 2.0
    ds_read_b128 v[44:47], v1 offset:22528
    s_waitcnt lgkmcnt(5)
    v_mfma_f32_16x16x32_bf16 v[72:75], v[24:27], v[120:123], v[72:75]
    v_rcp_f32 v89, v89
    v_rcp_f32 v92, v92
    ds_read_b128 v[48:51], v1 offset:7168
    s_waitcnt lgkmcnt(5)
    v_mfma_f32_16x16x32_bf16 v[76:79], v[28:31], v[120:123], v[76:79]
    v_fma_f32 v89, v89, s93, v252
    v_fma_f32 v92, v92, s93, v252
    ds_read_b128 v[52:55], v1 offset:23552
    s_waitcnt lgkmcnt(5)
    v_mfma_f32_16x16x32_bf16 v[72:75], v[32:35], v[124:127], v[72:75]
    v_mul_f32 v56, v56, v89
    v_mul_f32 v57, v57, v92
    ds_read_b128 v[24:27], v1 offset:8192
    s_waitcnt lgkmcnt(5)
    v_mfma_f32_16x16x32_bf16 v[76:79], v[36:39], v[124:127], v[76:79]
    v_fma_f32 v88, -v17, v98, v218
    v_fma_f32 v91, -v17, v99, v219
    ds_read_b128 v[28:31], v1 offset:24576
    s_waitcnt lgkmcnt(5)
    v_mfma_f32_16x16x32_bf16 v[72:75], v[40:43], v[128:131], v[72:75]
    v_fma_f32 v58, v58, v18, v88
    v_fma_f32 v59, v59, v18, v91
    ds_read_b128 v[32:35], v1 offset:9216
    s_waitcnt lgkmcnt(5)
    v_mfma_f32_16x16x32_bf16 v[76:79], v[44:47], v[128:131], v[76:79]
    v_exp_f32 v89, v58
    v_exp_f32 v92, v59
    ds_read_b128 v[36:39], v1 offset:25600
    s_waitcnt lgkmcnt(5)
    v_mfma_f32_16x16x32_bf16 v[72:75], v[48:51], v[132:135], v[72:75]
    v_add_f32 v90, 2.0, v89
    v_add_f32 v93, 2.0, v92
    ds_read_b128 v[40:43], v1 offset:10240
    s_waitcnt lgkmcnt(5)
    v_mfma_f32_16x16x32_bf16 v[76:79], v[52:55], v[132:135], v[76:79]
    v_fma_f32 v89, v89, v90, 2.0
    v_fma_f32 v92, v92, v93, 2.0
    ds_read_b128 v[44:47], v1 offset:26624
    s_waitcnt lgkmcnt(5)
    v_mfma_f32_16x16x32_bf16 v[72:75], v[24:27], v[136:139], v[72:75]
    v_rcp_f32 v89, v89
    v_rcp_f32 v92, v92
    ds_read_b128 v[48:51], v1 offset:11264
    s_waitcnt lgkmcnt(5)
    v_mfma_f32_16x16x32_bf16 v[76:79], v[28:31], v[136:139], v[76:79]
    v_fma_f32 v89, v89, s93, v252
    v_fma_f32 v92, v92, s93, v252
    ds_read_b128 v[52:55], v1 offset:27648
    s_waitcnt lgkmcnt(5)
    v_mfma_f32_16x16x32_bf16 v[72:75], v[32:35], v[140:143], v[72:75]
    v_mul_f32 v58, v58, v89
    v_mul_f32 v59, v59, v92
    ds_read_b128 v[24:27], v1 offset:12288
    s_waitcnt lgkmcnt(5)
    v_mfma_f32_16x16x32_bf16 v[76:79], v[36:39], v[140:143], v[76:79]
    v_fma_f32 v88, -v17, v100, v220
    v_fma_f32 v91, -v17, v101, v221
    ds_read_b128 v[28:31], v1 offset:28672
    s_waitcnt lgkmcnt(5)
    v_mfma_f32_16x16x32_bf16 v[72:75], v[40:43], v[144:147], v[72:75]
    v_fma_f32 v60, v60, v18, v88
    v_fma_f32 v61, v61, v18, v91
    ds_read_b128 v[32:35], v1 offset:13312
    s_waitcnt lgkmcnt(5)
    v_mfma_f32_16x16x32_bf16 v[76:79], v[44:47], v[144:147], v[76:79]
    v_exp_f32 v89, v60
    v_exp_f32 v92, v61
    ds_read_b128 v[36:39], v1 offset:29696
    s_waitcnt lgkmcnt(5)
    v_mfma_f32_16x16x32_bf16 v[72:75], v[48:51], v[148:151], v[72:75]
    v_add_f32 v90, 2.0, v89
    v_add_f32 v93, 2.0, v92
    ds_read_b128 v[40:43], v1 offset:14336
    s_waitcnt lgkmcnt(5)
    v_mfma_f32_16x16x32_bf16 v[76:79], v[52:55], v[148:151], v[76:79]
    v_fma_f32 v89, v89, v90, 2.0
    v_fma_f32 v92, v92, v93, 2.0
    ds_read_b128 v[44:47], v1 offset:30720
    s_waitcnt lgkmcnt(5)
    v_mfma_f32_16x16x32_bf16 v[72:75], v[24:27], v[152:155], v[72:75]
    v_rcp_f32 v89, v89
    v_rcp_f32 v92, v92
    ds_read_b128 v[48:51], v1 offset:15360
    s_waitcnt lgkmcnt(5)
    v_mfma_f32_16x16x32_bf16 v[76:79], v[28:31], v[152:155], v[76:79]
    v_fma_f32 v89, v89, s93, v252
    v_fma_f32 v92, v92, s93, v252
    ds_read_b128 v[52:55], v1 offset:31744
    s_waitcnt lgkmcnt(5)
    v_mfma_f32_16x16x32_bf16 v[72:75], v[32:35], v[156:159], v[72:75]
    v_mul_f32 v60, v60, v89
    v_mul_f32 v61, v61, v92
    s_waitcnt lgkmcnt(4)
    v_mfma_f32_16x16x32_bf16 v[76:79], v[36:39], v[156:159], v[76:79]
    v_fma_f32 v88, -v17, v102, v222
    v_fma_f32 v91, -v17, v103, v223
    s_waitcnt lgkmcnt(3)
    v_mfma_f32_16x16x32_bf16 v[72:75], v[40:43], v[160:163], v[72:75]
    v_fma_f32 v62, v62, v18, v88
    v_fma_f32 v63, v63, v18, v91
    s_waitcnt lgkmcnt(2)
    v_mfma_f32_16x16x32_bf16 v[76:79], v[44:47], v[160:163], v[76:79]
    v_exp_f32 v89, v62
    v_exp_f32 v92, v63
    s_waitcnt lgkmcnt(1)
    v_mfma_f32_16x16x32_bf16 v[72:75], v[48:51], v[164:167], v[72:75]
    v_add_f32 v90, 2.0, v89
    v_add_f32 v93, 2.0, v92
    s_waitcnt lgkmcnt(0)
    v_mfma_f32_16x16x32_bf16 v[76:79], v[52:55], v[164:167], v[76:79]
    v_fma_f32 v89, v89, v90, 2.0
    v_fma_f32 v92, v92, v93, 2.0
    s_setprio 0
    ds_read_b128 v[24:27], v19 offset:128
    ds_read_b128 v[28:31], v19 offset:192
    ds_read_b128 v[32:35], v19 offset:256
    ds_read_b128 v[36:39], v19 offset:320
    v_rcp_f32 v89, v89
    v_rcp_f32 v92, v92
    v_fma_f32 v89, v89, s93, v252
    v_fma_f32 v92, v92, s93, v252
    v_mul_f32 v62, v62, v89
    v_mul_f32 v63, v63, v92
    v_cvt_pk_bf16_f32 v56, v56, v57
    v_cvt_pk_bf16_f32 v57, v58, v59
    v_cvt_pk_bf16_f32 v58, v60, v61
    v_cvt_pk_bf16_f32 v59, v62, v63
    s_add_u32 s49, s56, s63
    s_add_u32 s49, s49, 0
    s_lshl_b32 s49, s49, 10
    s_add_u32 s49, s49, 6291456
    buffer_store_dwordx4 v[56:59], v1, s[40:43], s49 offen sc1
    s_waitcnt lgkmcnt(2)
    v_fma_f32 v88, -v17, v24, v224
    v_fma_f32 v91, -v17, v25, v225
    v_fma_f32 v64, v64, v18, v88
    v_fma_f32 v65, v65, v18, v91
    v_exp_f32 v89, v64
    v_exp_f32 v92, v65
    v_add_f32 v90, 2.0, v89
    v_add_f32 v93, 2.0, v92
    v_fma_f32 v89, v89, v90, 2.0
    v_fma_f32 v92, v92, v93, 2.0
    v_rcp_f32 v89, v89
    v_rcp_f32 v92, v92
    v_fma_f32 v89, v89, s93, v252
    v_fma_f32 v92, v92, s93, v252
    v_mul_f32 v64, v64, v89
    v_mul_f32 v65, v65, v92
    v_fma_f32 v88, -v17, v26, v226
    v_fma_f32 v91, -v17, v27, v227
    v_fma_f32 v66, v66, v18, v88
    v_fma_f32 v67, v67, v18, v91
    v_exp_f32 v89, v66
    v_exp_f32 v92, v67
    v_add_f32 v90, 2.0, v89
    v_add_f32 v93, 2.0, v92
    v_fma_f32 v89, v89, v90, 2.0
    v_fma_f32 v92, v92, v93, 2.0
    v_rcp_f32 v89, v89
    v_rcp_f32 v92, v92
    v_fma_f32 v89, v89, s93, v252
    v_fma_f32 v92, v92, s93, v252
    v_mul_f32 v66, v66, v89
    v_mul_f32 v67, v67, v92
    v_fma_f32 v88, -v17, v28, v228
    v_fma_f32 v91, -v17, v29, v229
    v_fma_f32 v68, v68, v18, v88
    v_fma_f32 v69, v69, v18, v91
    v_exp_f32 v89, v68
    v_exp_f32 v92, v69
    v_add_f32 v90, 2.0, v89
    v_add_f32 v93, 2.0, v92
    v_fma_f32 v89, v89, v90, 2.0
    v_fma_f32 v92, v92, v93, 2.0
    v_rcp_f32 v89, v89
    v_rcp_f32 v92, v92
    v_fma_f32 v89, v89, s93, v252
    v_fma_f32 v92, v92, s93, v252
    v_mul_f32 v68, v68, v89
    v_mul_f32 v69, v69, v92
    v_fma_f32 v88, -v17, v30, v230
    v_fma_f32 v91, -v17, v31, v231
    v_fma_f32 v70, v70, v18, v88
    v_fma_f32 v71, v71, v18, v91
    v_exp_f32 v89, v70
    v_exp_f32 v92, v71
    v_add_f32 v90, 2.0, v89
    v_add_f32 v93, 2.0, v92
    v_fma_f32 v89, v89, v90, 2.0
    v_fma_f32 v92, v92, v93, 2.0
    v_rcp_f32 v89, v89
    v_rcp_f32 v92, v92
    v_fma_f32 v89, v89, s93, v252
    v_fma_f32 v92, v92, s93, v252
    v_mul_f32 v70, v70, v89
    v_mul_f32 v71, v71, v92
    v_cvt_pk_bf16_f32 v64, v64, v65
    v_cvt_pk_bf16_f32 v65, v66, v67
    v_cvt_pk_bf16_f32 v66, v68, v69
    v_cvt_pk_bf16_f32 v67, v70, v71
    s_add_u32 s49, s56, s63
    s_add_u32 s49, s49, 1
    s_lshl_b32 s49, s49, 10
    s_add_u32 s49, s49, 6291456
    buffer_store_dwordx4 v[64:67], v1, s[40:43], s49 offen sc1
    s_waitcnt lgkmcnt(0)
    v_fma_f32 v88, -v17, v32, v232
    v_fma_f32 v91, -v17, v33, v233
    v_fma_f32 v72, v72, v18, v88
    v_fma_f32 v73, v73, v18, v91
    v_exp_f32 v89, v72
    v_exp_f32 v92, v73
    v_add_f32 v90, 2.0, v89
    v_add_f32 v93, 2.0, v92
    v_fma_f32 v89, v89, v90, 2.0
    v_fma_f32 v92, v92, v93, 2.0
    v_rcp_f32 v89, v89
    v_rcp_f32 v92, v92
    v_fma_f32 v89, v89, s93, v252
    v_fma_f32 v92, v92, s93, v252
    v_mul_f32 v72, v72, v89
    v_mul_f32 v73, v73, v92
    v_fma_f32 v88, -v17, v34, v234
    v_fma_f32 v91, -v17, v35, v235
    v_fma_f32 v74, v74, v18, v88
    v_fma_f32 v75, v75, v18, v91
    v_exp_f32 v89, v74
    v_exp_f32 v92, v75
    v_add_f32 v90, 2.0, v89
    v_add_f32 v93, 2.0, v92
    v_fma_f32 v89, v89, v90, 2.0
    v_fma_f32 v92, v92, v93, 2.0
    v_rcp_f32 v89, v89
    v_rcp_f32 v92, v92
    v_fma_f32 v89, v89, s93, v252
    v_fma_f32 v92, v92, s93, v252
    v_mul_f32 v74, v74, v89
    v_mul_f32 v75, v75, v92
    v_fma_f32 v88, -v17, v36, v236
    v_fma_f32 v91, -v17, v37, v237
    v_fma_f32 v76, v76, v18, v88
    v_fma_f32 v77, v77, v18, v91
    v_exp_f32 v89, v76
    v_exp_f32 v92, v77
    v_add_f32 v90, 2.0, v89
    v_add_f32 v93, 2.0, v92
    v_fma_f32 v89, v89, v90, 2.0
    v_fma_f32 v92, v92, v93, 2.0
    v_rcp_f32 v89, v89
    v_rcp_f32 v92, v92
    v_fma_f32 v89, v89, s93, v252
    v_fma_f32 v92, v92, s93, v252
    v_mul_f32 v76, v76, v89
    v_mul_f32 v77, v77, v92
    v_fma_f32 v88, -v17, v38, v238
    v_fma_f32 v91, -v17, v39, v239
    v_fma_f32 v78, v78, v18, v88
    v_fma_f32 v79, v79, v18, v91
    v_exp_f32 v89, v78
    v_exp_f32 v92, v79
    v_add_f32 v90, 2.0, v89
    v_add_f32 v93, 2.0, v92
    v_fma_f32 v89, v89, v90, 2.0
    v_fma_f32 v92, v92, v93, 2.0
    v_rcp_f32 v89, v89
    v_rcp_f32 v92, v92
    v_fma_f32 v89, v89, s93, v252
    v_fma_f32 v92, v92, s93, v252
    v_mul_f32 v78, v78, v89
    v_mul_f32 v79, v79, v92
    v_cvt_pk_bf16_f32 v72, v72, v73
    v_cvt_pk_bf16_f32 v73, v74, v75
    v_cvt_pk_bf16_f32 v74, v76, v77
    v_cvt_pk_bf16_f32 v75, v78, v79
    s_add_u32 s49, s6, s63
    s_add_u32 s49, s49, 0
    s_lshl_b32 s49, s49, 10
    s_add_u32 s49, s49, 6291456
    buffer_store_dwordx4 v[72:75], v1, s[40:43], s49 offen sc1
    s_lshl_b32 s47, s44, 4
    s_add_u32 s47, s47, s45
    s_add_u32 s47, s47, 768
    s_lshl_b32 s47, s47, 7
    s_lshl_b32 s48, s46, 3
    s_add_u32 s47, s47, s48
    v_mov_b32 v14, s59
    v_not_b32 v15, s59
    s_mov_b64 s[90:91], exec
    s_mov_b64 exec, 1
    s_waitcnt vmcnt(0)
    buffer_store_dwordx2 v[14:15], v7, s[40:43], s47 offen sc1
    s_mov_b64 exec, s[90:91]
    s_barrier
    s_lshl_b32 s47, s46, 12
    v_add_u32 v86, s47, v1
    s_lshl_b32 s47, s46, 13
    s_add_u32 s47, s47, 81920
    v_add_u32 v87, s47, v1
    ds_write_b128 v86, v[168:171] offset:0
    ds_write_b128 v86, v[172:175] offset:1024
    ds_write_b128 v86, v[176:179] offset:2048
    ds_write_b128 v86, v[180:183] offset:3072
    ds_write_b128 v87, v[184:187] offset:0
    ds_write_b128 v87, v[188:191] offset:1024
    ds_write_b128 v87, v[192:195] offset:2048
    ds_write_b128 v87, v[196:199] offset:3072
    ds_write_b128 v87, v[200:203] offset:4096
    ds_write_b128 v87, v[204:207] offset:5120
    ds_write_b128 v87, v[208:211] offset:6144
    ds_write_b128 v87, v[212:215] offset:7168
    s_waitcnt lgkmcnt(0)
    s_mul_i32 s49, s53, 43
    s_lshl_b32 s49, s49, 10
    s_add_u32 s49, s49, 6291456
    s_lshl_b32 s51, s54, 13
    s_mul_i32 s50, s7, 180224
    s_add_u32 s50, s50, s51
    s_add_u32 s50, s50, 15888384
    buffer_load_dwordx4 v[192:195], v1, s[40:43], s50 offen offset:0 sc1
    buffer_load_dwordx4 v[196:199], v1, s[40:43], s50 offen offset:1024 sc1
    buffer_load_dwordx4 v[200:203], v1, s[40:43], s50 offen offset:2048 sc1
    buffer_load_dwordx4 v[204:207], v1, s[40:43], s50 offen offset:3072 sc1
    s_add_u32 s50, s50, 4096
    buffer_load_dwordx4 v[208:211], v1, s[40:43], s50 offen offset:0 sc1
    buffer_load_dwordx4 v[212:215], v1, s[40:43], s50 offen offset:1024 sc1
    buffer_load_dwordx4 v[216:219], v1, s[40:43], s50 offen offset:2048 sc1
    buffer_load_dwordx4 v[220:223], v1, s[40:43], s50 offen offset:3072 sc1
    s_waitcnt vmcnt(0)
    s_cmp_lg_u32 s46, 0
    s_cbranch_scc1 L_pskip_23
    v_lshrrev_b32 v86, 2, v80
    v_lshlrev_b32 v86, 7, v86
    v_lshl_add_u32 v86, v83, 4, v86
    s_add_u32 s47, s44, 48
    s_lshl_b32 s47, s47, 11
    s_mov_b32 s57, 0
    s_not_b32 s48, s59
L_poll_24:
    buffer_load_dwordx4 v[88:91], v86, s[40:43], s47 offen sc1
    s_add_u32 s57, s57, 1
    s_waitcnt vmcnt(0)
    v_xor_b32 v88, s59, v88
    v_xor_b32 v89, s48, v89
    v_xor_b32 v90, s59, v90
    v_xor_b32 v91, s48, v91
    v_or_b32 v88, v88, v89
    v_or_b32 v90, v90, v91
    v_or_b32 v88, v88, v90
    v_cmp_eq_u32 vcc, 0, v88
    s_cmp_gt_u32 s57, 200000
    s_cbranch_scc1 L_pskip_23
    s_cmp_eq_u64 vcc, exec
    s_cbranch_scc0 L_poll_24
L_pskip_23:
    s_barrier
    s_cmp_eq_u32 s54, 0
    s_cbranch_scc0 L_p4k1
    buffer_load_dwordx4 v[104:107], v1, s[40:43], s49 offen offset:0 sc1
    buffer_load_dwordx4 v[108:111], v1, s[40:43], s49 offen offset:1024 sc1
    buffer_load_dwordx4 v[112:115], v1, s[40:43], s49 offen offset:2048 sc1
    buffer_load_dwordx4 v[116:119], v1, s[40:43], s49 offen offset:3072 sc1
    s_add_u32 s49, s49, 4096
    buffer_load_dwordx4 v[120:123], v1, s[40:43], s49 offen offset:0 sc1
    buffer_load_dwordx4 v[124:127], v1, s[40:43], s49 offen offset:1024 sc1
    buffer_load_dwordx4 v[128:131], v1, s[40:43], s49 offen offset:2048 sc1
    buffer_load_dwordx4 v[132:135], v1, s[40:43], s49 offen offset:3072 sc1
    s_setprio 2
    ds_read_b128 v[24:27], v1 offset:0
    ds_read_b128 v[28:31], v1 offset:1024
    ds_read_b128 v[32:35], v1 offset:2048
    ds_read_b128 v[36:39], v1 offset:3072
    ds_read_b128 v[40:43], v1 offset:4096
    ds_read_b128 v[44:47], v1 offset:5120
    s_waitcnt vmcnt(7)
    s_waitcnt lgkmcnt(5)
    v_mfma_f32_16x16x32_bf16 v[56:59], v[24:27], v[104:107], 0
    s_add_u32 s49, s49, 4096
    buffer_load_dwordx4 v[136:139], v1, s[40:43], s49 offen offset:0 sc1
    ds_read_b128 v[48:51], v1 offset:6144
    s_waitcnt lgkmcnt(5)
    v_mfma_f32_16x16x32_bf16 v[60:63], v[28:31], v[104:107], 0
    ds_read_b128 v[52:55], v1 offset:7168
    s_waitcnt lgkmcnt(5)
    v_mfma_f32_16x16x32_bf16 v[64:67], v[32:35], v[104:107], 0
    ds_read_b128 v[24:27], v1 offset:8192
    s_waitcnt lgkmcnt(5)
    v_mfma_f32_16x16x32_bf16 v[68:71], v[36:39], v[104:107], 0
    ds_read_b128 v[28:31], v1 offset:9216
    s_waitcnt vmcnt(7)
    s_waitcnt lgkmcnt(5)
    v_mfma_f32_16x16x32_bf16 v[56:59], v[40:43], v[108:111], v[56:59]
    buffer_load_dwordx4 v[140:143], v1, s[40:43], s49 offen offset:1024 sc1
    ds_read_b128 v[32:35], v1 offset:10240
    s_waitcnt lgkmcnt(5)
    v_mfma_f32_16x16x32_bf16 v[60:63], v[44:47], v[108:111], v[60:63]
    ds_read_b128 v[36:39], v1 offset:11264
    s_waitcnt lgkmcnt(5)
    v_mfma_f32_16x16x32_bf16 v[64:67], v[48:51], v[108:111], v[64:67]
    ds_read_b128 v[40:43], v1 offset:12288
    s_waitcnt lgkmcnt(5)
    v_mfma_f32_16x16x32_bf16 v[68:71], v[52:55], v[108:111], v[68:71]
    ds_read_b128 v[44:47], v1 offset:13312
    s_waitcnt vmcnt(7)
    s_waitcnt lgkmcnt(5)
    v_mfma_f32_16x16x32_bf16 v[56:59], v[24:27], v[112:115], v[56:59]
    buffer_load_dwordx4 v[144:147], v1, s[40:43], s49 offen offset:2048 sc1
    ds_read_b128 v[48:51], v1 offset:14336
    s_waitcnt lgkmcnt(5)
    v_mfma_f32_16x16x32_bf16 v[60:63], v[28:31], v[112:115], v[60:63]
    ds_read_b128 v[52:55], v1 offset:15360
    s_waitcnt lgkmcnt(5)
    v_mfma_f32_16x16x32_bf16 v[64:67], v[32:35], v[112:115], v[64:67]
    ds_read_b128 v[24:27], v1 offset:16384
    s_waitcnt lgkmcnt(5)
    v_mfma_f32_16x16x32_bf16 v[68:71], v[36:39], v[112:115], v[68:71]
    ds_read_b128 v[28:31], v1 offset:17408
    s_waitcnt vmcnt(7)
    s_waitcnt lgkmcnt(5)
    v_mfma_f32_16x16x32_bf16 v[56:59], v[40:43], v[116:119], v[56:59]
    buffer_load_dwordx4 v[148:151], v1, s[40:43], s49 offen offset:3072 sc1
    ds_read_b128 v[32:35], v1 offset:18432
    s_waitcnt lgkmcnt(5)
    v_mfma_f32_16x16x32_bf16 v[60:63], v[44:47], v[116:119], v[60:63]
    ds_read_b128 v[36:39], v1 offset:19456
    s_waitcnt lgkmcnt(5)
    v_mfma_f32_16x16x32_bf16 v[64:67], v[48:51], v[116:119], v[64:67]
    ds_read_b128 v[40:43], v1 offset:20480
    s_waitcnt lgkmcnt(5)
    v_mfma_f32_16x16x32_bf16 v[68:71], v[52:55], v[116:119], v[68:71]
    ds_read_b128 v[44:47], v1 offset:21504
    s_waitcnt vmcnt(7)
    s_waitcnt lgkmcnt(5)
    v_mfma_f32_16x16x32_bf16 v[56:59], v[24:27], v[120:123], v[56:59]
    s_add_u32 s49, s49, 4096
    buffer_load_dwordx4 v[152:155], v1, s[40:43], s49 offen offset:0 sc1
    ds_read_b128 v[48:51], v1 offset:22528
    s_waitcnt lgkmcnt(5)
    v_mfma_f32_16x16x32_bf16 v[60:63], v[28:31], v[120:123], v[60:63]
    ds_read_b128 v[52:55], v1 offset:23552
    s_waitcnt lgkmcnt(5)
    v_mfma_f32_16x16x32_bf16 v[64:67], v[32:35], v[120:123], v[64:67]
    ds_read_b128 v[24:27], v1 offset:24576
    s_waitcnt lgkmcnt(5)
    v_mfma_f32_16x16x32_bf16 v[68:71], v[36:39], v[120:123], v[68:71]
    ds_read_b128 v[28:31], v1 offset:25600
    s_waitcnt vmcnt(7)
    s_waitcnt lgkmcnt(5)
    v_mfma_f32_16x16x32_bf16 v[56:59], v[40:43], v[124:127], v[56:59]
    buffer_load_dwordx4 v[156:159], v1, s[40:43], s49 offen offset:1024 sc1
    ds_read_b128 v[32:35], v1 offset:26624
    s_waitcnt lgkmcnt(5)
    v_mfma_f32_16x16x32_bf16 v[60:63], v[44:47], v[124:127], v[60:63]
    ds_read_b128 v[36:39], v1 offset:27648
    s_waitcnt lgkmcnt(5)
    v_mfma_f32_16x16x32_bf16 v[64:67], v[48:51], v[124:127], v[64:67]
    ds_read_b128 v[40:43], v1 offset:28672
    s_waitcnt lgkmcnt(5)
    v_mfma_f32_16x16x32_bf16 v[68:71], v[52:55], v[124:127], v[68:71]
    ds_read_b128 v[44:47], v1 offset:29696
    s_waitcnt vmcnt(7)
    s_waitcnt lgkmcnt(5)
    v_mfma_f32_16x16x32_bf16 v[56:59], v[24:27], v[128:131], v[56:59]
    buffer_load_dwordx4 v[160:163], v1, s[40:43], s49 offen offset:2048 sc1
    ds_read_b128 v[48:51], v1 offset:30720
    s_waitcnt lgkmcnt(5)
    v_mfma_f32_16x16x32_bf16 v[60:63], v[28:31], v[128:131], v[60:63]
    ds_read_b128 v[52:55], v1 offset:31744
    s_waitcnt lgkmcnt(5)
    v_mfma_f32_16x16x32_bf16 v[64:67], v[32:35], v[128:131], v[64:67]
    ds_read_b128 v[24:27], v1 offset:32768
    s_waitcnt lgkmcnt(5)
    v_mfma_f32_16x16x32_bf16 v[68:71], v[36:39], v[128:131], v[68:71]
    ds_read_b128 v[28:31], v1 offset:33792
    s_waitcnt vmcnt(7)
    s_waitcnt lgkmcnt(5)
    v_mfma_f32_16x16x32_bf16 v[56:59], v[40:43], v[132:135], v[56:59]
    buffer_load_dwordx4 v[164:167], v1, s[40:43], s49 offen offset:3072 sc1
    ds_read_b128 v[32:35], v1 offset:34816
    s_waitcnt lgkmcnt(5)
    v_mfma_f32_16x16x32_bf16 v[60:63], v[44:47], v[132:135], v[60:63]
    ds_read_b128 v[36:39], v1 offset:35840
    s_waitcnt lgkmcnt(5)
    v_mfma_f32_16x16x32_bf16 v[64:67], v[48:51], v[132:135], v[64:67]
    ds_read_b128 v[40:43], v1 offset:36864
    s_waitcnt lgkmcnt(5)
    v_mfma_f32_16x16x32_bf16 v[68:71], v[52:55], v[132:135], v[68:71]
    ds_read_b128 v[44:47], v1 offset:37888
    s_waitcnt vmcnt(7)
    s_waitcnt lgkmcnt(5)
    v_mfma_f32_16x16x32_bf16 v[56:59], v[24:27], v[136:139], v[56:59]
    s_add_u32 s49, s49, 4096
    buffer_load_dwordx4 v[168:171], v1, s[40:43], s49 offen offset:0 sc1
    ds_read_b128 v[48:51], v1 offset:38912
    s_waitcnt lgkmcnt(5)
    v_mfma_f32_16x16x32_bf16 v[60:63], v[28:31], v[136:139], v[60:63]
    ds_read_b128 v[52:55], v1 offset:39936
    s_waitcnt lgkmcnt(5)
    v_mfma_f32_16x16x32_bf16 v[64:67], v[32:35], v[136:139], v[64:67]
    ds_read_b128 v[24:27], v1 offset:40960
    s_waitcnt lgkmcnt(5)
    v_mfma_f32_16x16x32_bf16 v[68:71], v[36:39], v[136:139], v[68:71]
    ds_read_b128 v[28:31], v1 offset:41984
    s_waitcnt vmcnt(7)
    s_waitcnt lgkmcnt(5)
    v_mfma_f32_16x16x32_bf16 v[56:59], v[40:43], v[140:143], v[56:59]
    buffer_load_dwordx4 v[172:175], v1, s[40:43], s49 offen offset:1024 sc1
    ds_read_b128 v[32:35], v1 offset:43008
    s_waitcnt lgkmcnt(5)
    v_mfma_f32_16x16x32_bf16 v[60:63], v[44:47], v[140:143], v[60:63]
    ds_read_b128 v[36:39], v1 offset:44032
    s_waitcnt lgkmcnt(5)
    v_mfma_f32_16x16x32_bf16 v[64:67], v[48:51], v[140:143], v[64:67]
    ds_read_b128 v[40:43], v1 offset:45056
    s_waitcnt lgkmcnt(5)
    v_mfma_f32_16x16x32_bf16 v[68:71], v[52:55], v[140:143], v[68:71]
    ds_read_b128 v[44:47], v1 offset:46080
    s_waitcnt vmcnt(7)
    s_waitcnt lgkmcnt(5)
    v_mfma_f32_16x16x32_bf16 v[56:59], v[24:27], v[144:147], v[56:59]
    buffer_load_dwordx4 v[176:179], v1, s[40:43], s49 offen offset:2048 sc1
    ds_read_b128 v[48:51], v1 offset:47104
    s_waitcnt lgkmcnt(5)
    v_mfma_f32_16x16x32_bf16 v[60:63], v[28:31], v[144:147], v[60:63]
    ds_read_b128 v[52:55], v1 offset:48128
    s_waitcnt lgkmcnt(5)
    v_mfma_f32_16x16x32_bf16 v[64:67], v[32:35], v[144:147], v[64:67]
    ds_read_b128 v[24:27], v1 offset:49152
    s_waitcnt lgkmcnt(5)
    v_mfma_f32_16x16x32_bf16 v[68:71], v[36:39], v[144:147], v[68:71]
    ds_read_b128 v[28:31], v1 offset:50176
    s_waitcnt vmcnt(7)
    s_waitcnt lgkmcnt(5)
    v_mfma_f32_16x16x32_bf16 v[56:59], v[40:43], v[148:151], v[56:59]
    buffer_load_dwordx4 v[180:183], v1, s[40:43], s49 offen offset:3072 sc1
    ds_read_b128 v[32:35], v1 offset:51200
    s_waitcnt lgkmcnt(5)
    v_mfma_f32_16x16x32_bf16 v[60:63], v[44:47], v[148:151], v[60:63]
    ds_read_b128 v[36:39], v1 offset:52224
    s_waitcnt lgkmcnt(5)
    v_mfma_f32_16x16x32_bf16 v[64:67], v[48:51], v[148:151], v[64:67]
    ds_read_b128 v[40:43], v1 offset:53248
    s_waitcnt lgkmcnt(5)
    v_mfma_f32_16x16x32_bf16 v[68:71], v[52:55], v[148:151], v[68:71]
    ds_read_b128 v[44:47], v1 offset:54272
    s_waitcnt vmcnt(7)
    s_waitcnt lgkmcnt(5)
    v_mfma_f32_16x16x32_bf16 v[56:59], v[24:27], v[152:155], v[56:59]
    s_add_u32 s49, s49, 20480
    buffer_load_dwordx4 v[184:187], v1, s[40:43], s49 offen offset:3072 sc1
    ds_read_b128 v[48:51], v1 offset:55296
    s_waitcnt lgkmcnt(5)
    v_mfma_f32_16x16x32_bf16 v[60:63], v[28:31], v[152:155], v[60:63]
    ds_read_b128 v[52:55], v1 offset:56320
    s_waitcnt lgkmcnt(5)
    v_mfma_f32_16x16x32_bf16 v[64:67], v[32:35], v[152:155], v[64:67]
    ds_read_b128 v[24:27], v1 offset:57344
    s_waitcnt lgkmcnt(5)
    v_mfma_f32_16x16x32_bf16 v[68:71], v[36:39], v[152:155], v[68:71]
    ds_read_b128 v[28:31], v1 offset:58368
    s_waitcnt vmcnt(7)
    s_waitcnt lgkmcnt(5)
    v_mfma_f32_16x16x32_bf16 v[56:59], v[40:43], v[156:159], v[56:59]
    s_add_u32 s49, s49, 4096
    buffer_load_dwordx4 v[188:191], v1, s[40:43], s49 offen offset:0 sc1
    ds_read_b128 v[32:35], v1 offset:59392
    s_waitcnt lgkmcnt(5)
    v_mfma_f32_16x16x32_bf16 v[60:63], v[44:47], v[156:159], v[60:63]
    ds_read_b128 v[36:39], v1 offset:60416
    s_waitcnt lgkmcnt(5)
    v_mfma_f32_16x16x32_bf16 v[64:67], v[48:51], v[156:159], v[64:67]
    ds_read_b128 v[40:43], v1 offset:61440
    s_waitcnt lgkmcnt(5)
    v_mfma_f32_16x16x32_bf16 v[68:71], v[52:55], v[156:159], v[68:71]
    ds_read_b128 v[44:47], v1 offset:62464
    s_waitcnt vmcnt(7)
    s_waitcnt lgkmcnt(5)
    v_mfma_f32_16x16x32_bf16 v[56:59], v[24:27], v[160:163], v[56:59]
    ds_read_b128 v[48:51], v1 offset:63488
    s_waitcnt lgkmcnt(5)
    v_mfma_f32_16x16x32_bf16 v[60:63], v[28:31], v[160:163], v[60:63]
    ds_read_b128 v[52:55], v1 offset:64512
    s_waitcnt lgkmcnt(5)
    v_mfma_f32_16x16x32_bf16 v[64:67], v[32:35], v[160:163], v[64:67]
    ds_read_b128 v[24:27], v3 offset:0
    s_waitcnt lgkmcnt(5)
    v_mfma_f32_16x16x32_bf16 v[68:71], v[36:39], v[160:163], v[68:71]
    ds_read_b128 v[28:31], v3 offset:1024
    s_waitcnt vmcnt(6)
    s_waitcnt lgkmcnt(5)
    v_mfma_f32_16x16x32_bf16 v[56:59], v[40:43], v[164:167], v[56:59]
    ds_read_b128 v[32:35], v3 offset:2048
    s_waitcnt lgkmcnt(5)
    v_mfma_f32_16x16x32_bf16 v[60:63], v[44:47], v[164:167], v[60:63]
    ds_read_b128 v[36:39], v3 offset:3072
    s_waitcnt lgkmcnt(5)
    v_mfma_f32_16x16x32_bf16 v[64:67], v[48:51], v[164:167], v[64:67]
    ds_read_b128 v[40:43], v3 offset:4096
    s_waitcnt lgkmcnt(5)
    v_mfma_f32_16x16x32_bf16 v[68:71], v[52:55], v[164:167], v[68:71]
    ds_read_b128 v[44:47], v3 offset:5120
    s_waitcnt vmcnt(5)
    s_waitcnt lgkmcnt(5)
    v_mfma_f32_16x16x32_bf16 v[56:59], v[24:27], v[168:171], v[56:59]
    ds_read_b128 v[48:51], v3 offset:6144
    s_waitcnt lgkmcnt(5)
    v_mfma_f32_16x16x32_bf16 v[60:63], v[28:31], v[168:171], v[60:63]
    ds_read_b128 v[52:55], v3 offset:7168
    s_waitcnt lgkmcnt(5)
    v_mfma_f32_16x16x32_bf16 v[64:67], v[32:35], v[168:171], v[64:67]
    ds_read_b128 v[24:27], v3 offset:8192
    s_waitcnt lgkmcnt(5)
    v_mfma_f32_16x16x32_bf16 v[68:71], v[36:39], v[168:171], v[68:71]
    ds_read_b128 v[28:31], v3 offset:9216
    s_waitcnt vmcnt(4)
    s_waitcnt lgkmcnt(5)
    v_mfma_f32_16x16x32_bf16 v[56:59], v[40:43], v[172:175], v[56:59]
    ds_read_b128 v[32:35], v3 offset:10240
    s_waitcnt lgkmcnt(5)
    v_mfma_f32_16x16x32_bf16 v[60:63], v[44:47], v[172:175], v[60:63]
    ds_read_b128 v[36:39], v3 offset:11264
    s_waitcnt lgkmcnt(5)
    v_mfma_f32_16x16x32_bf16 v[64:67], v[48:51], v[172:175], v[64:67]
    ds_read_b128 v[40:43], v3 offset:12288
    s_waitcnt lgkmcnt(5)
    v_mfma_f32_16x16x32_bf16 v[68:71], v[52:55], v[172:175], v[68:71]
    ds_read_b128 v[44:47], v3 offset:13312
    s_waitcnt vmcnt(3)
    s_waitcnt lgkmcnt(5)
    v_mfma_f32_16x16x32_bf16 v[56:59], v[24:27], v[176:179], v[56:59]
    ds_read_b128 v[48:51], v3 offset:14336
    s_waitcnt lgkmcnt(5)
    v_mfma_f32_16x16x32_bf16 v[60:63], v[28:31], v[176:179], v[60:63]
    ds_read_b128 v[52:55], v3 offset:15360
    s_waitcnt lgkmcnt(5)
    v_mfma_f32_16x16x32_bf16 v[64:67], v[32:35], v[176:179], v[64:67]
    s_waitcnt lgkmcnt(4)
    v_mfma_f32_16x16x32_bf16 v[68:71], v[36:39], v[176:179], v[68:71]
    s_waitcnt vmcnt(2)
    s_waitcnt lgkmcnt(3)
    v_mfma_f32_16x16x32_bf16 v[56:59], v[40:43], v[180:183], v[56:59]
    s_waitcnt lgkmcnt(2)
    v_mfma_f32_16x16x32_bf16 v[60:63], v[44:47], v[180:183], v[60:63]
    s_waitcnt lgkmcnt(1)
    v_mfma_f32_16x16x32_bf16 v[64:67], v[48:51], v[180:183], v[64:67]
    s_waitcnt lgkmcnt(0)
    v_mfma_f32_16x16x32_bf16 v[68:71], v[52:55], v[180:183], v[68:71]
    s_setprio 0
    s_setprio 2
    s_waitcnt vmcnt(1)
    v_mfma_f32_16x16x32_bf16 v[56:59], v[192:195], v[184:187], v[56:59]
    v_mfma_f32_16x16x32_bf16 v[60:63], v[196:199], v[184:187], v[60:63]
    v_mfma_f32_16x16x32_bf16 v[64:67], v[200:203], v[184:187], v[64:67]
    v_mfma_f32_16x16x32_bf16 v[68:71], v[204:207], v[184:187], v[68:71]
    s_waitcnt vmcnt(0)
    v_mfma_f32_16x16x32_bf16 v[56:59], v[208:211], v[188:191], v[56:59]
    v_mfma_f32_16x16x32_bf16 v[60:63], v[212:215], v[188:191], v[60:63]
    v_mfma_f32_16x16x32_bf16 v[64:67], v[216:219], v[188:191], v[64:67]
    v_mfma_f32_16x16x32_bf16 v[68:71], v[220:223], v[188:191], v[68:71]
    s_setprio 0
    s_branch L_p4done
L_p4k1:
    s_add_u32 s49, s49, 20480
    buffer_load_dwordx4 v[104:107], v1, s[40:43], s49 offen offset:0 sc1
    buffer_load_dwordx4 v[108:111], v1, s[40:43], s49 offen offset:1024 sc1
    buffer_load_dwordx4 v[112:115], v1, s[40:43], s49 offen offset:2048 sc1
    buffer_load_dwordx4 v[116:119], v1, s[40:43], s49 offen offset:3072 sc1
    s_add_u32 s49, s49, 4096
    buffer_load_dwordx4 v[120:123], v1, s[40:43], s49 offen offset:0 sc1
    buffer_load_dwordx4 v[124:127], v1, s[40:43], s49 offen offset:1024 sc1
    buffer_load_dwordx4 v[128:131], v1, s[40:43], s49 offen offset:2048 sc1
    buffer_load_dwordx4 v[132:135], v1, s[40:43], s49 offen offset:3072 sc1
    s_setprio 2
    ds_read_b128 v[24:27], v3 offset:16384
    ds_read_b128 v[28:31], v3 offset:17408
    ds_read_b128 v[32:35], v3 offset:18432
    ds_read_b128 v[36:39], v3 offset:19456
    ds_read_b128 v[40:43], v3 offset:20480
    ds_read_b128 v[44:47], v3 offset:21504
    s_waitcnt vmcnt(7)
    s_waitcnt lgkmcnt(5)
    v_mfma_f32_16x16x32_bf16 v[56:59], v[24:27], v[104:107], 0
    s_add_u32 s49, s49, 4096
    buffer_load_dwordx4 v[136:139], v1, s[40:43], s49 offen offset:0 sc1
    ds_read_b128 v[48:51], v3 offset:22528
    s_waitcnt lgkmcnt(5)
    v_mfma_f32_16x16x32_bf16 v[60:63], v[28:31], v[104:107], 0
    ds_read_b128 v[52:55], v3 offset:23552
    s_waitcnt lgkmcnt(5)
    v_mfma_f32_16x16x32_bf16 v[64:67], v[32:35], v[104:107], 0
    ds_read_b128 v[24:27], v3 offset:24576
    s_waitcnt lgkmcnt(5)
    v_mfma_f32_16x16x32_bf16 v[68:71], v[36:39], v[104:107], 0
    ds_read_b128 v[28:31], v3 offset:25600
    s_waitcnt vmcnt(7)
    s_waitcnt lgkmcnt(5)
    v_mfma_f32_16x16x32_bf16 v[56:59], v[40:43], v[108:111], v[56:59]
    buffer_load_dwordx4 v[140:143], v1, s[40:43], s49 offen offset:1024 sc1
    ds_read_b128 v[32:35], v3 offset:26624
    s_waitcnt lgkmcnt(5)
    v_mfma_f32_16x16x32_bf16 v[60:63], v[44:47], v[108:111], v[60:63]
    ds_read_b128 v[36:39], v3 offset:27648
    s_waitcnt lgkmcnt(5)
    v_mfma_f32_16x16x32_bf16 v[64:67], v[48:51], v[108:111], v[64:67]
    ds_read_b128 v[40:43], v3 offset:28672
    s_waitcnt lgkmcnt(5)
    v_mfma_f32_16x16x32_bf16 v[68:71], v[52:55], v[108:111], v[68:71]
    ds_read_b128 v[44:47], v3 offset:29696
    s_waitcnt vmcnt(7)
    s_waitcnt lgkmcnt(5)
    v_mfma_f32_16x16x32_bf16 v[56:59], v[24:27], v[112:115], v[56:59]
    buffer_load_dwordx4 v[144:147], v1, s[40:43], s49 offen offset:2048 sc1
    ds_read_b128 v[48:51], v3 offset:30720
    s_waitcnt lgkmcnt(5)
    v_mfma_f32_16x16x32_bf16 v[60:63], v[28:31], v[112:115], v[60:63]
    ds_read_b128 v[52:55], v3 offset:31744
    s_waitcnt lgkmcnt(5)
    v_mfma_f32_16x16x32_bf16 v[64:67], v[32:35], v[112:115], v[64:67]
    ds_read_b128 v[24:27], v3 offset:32768
    s_waitcnt lgkmcnt(5)
    v_mfma_f32_16x16x32_bf16 v[68:71], v[36:39], v[112:115], v[68:71]
    ds_read_b128 v[28:31], v3 offset:33792
    s_waitcnt vmcnt(7)
    s_waitcnt lgkmcnt(5)
    v_mfma_f32_16x16x32_bf16 v[56:59], v[40:43], v[116:119], v[56:59]
    buffer_load_dwordx4 v[148:151], v1, s[40:43], s49 offen offset:3072 sc1
    ds_read_b128 v[32:35], v3 offset:34816
    s_waitcnt lgkmcnt(5)
    v_mfma_f32_16x16x32_bf16 v[60:63], v[44:47], v[116:119], v[60:63]
    ds_read_b128 v[36:39], v3 offset:35840
    s_waitcnt lgkmcnt(5)
    v_mfma_f32_16x16x32_bf16 v[64:67], v[48:51], v[116:119], v[64:67]
    ds_read_b128 v[40:43], v3 offset:36864
    s_waitcnt lgkmcnt(5)
    v_mfma_f32_16x16x32_bf16 v[68:71], v[52:55], v[116:119], v[68:71]
    ds_read_b128 v[44:47], v3 offset:37888
    s_waitcnt vmcnt(7)
    s_waitcnt lgkmcnt(5)
    v_mfma_f32_16x16x32_bf16 v[56:59], v[24:27], v[120:123], v[56:59]
    s_add_u32 s49, s49, 4096
    buffer_load_dwordx4 v[152:155], v1, s[40:43], s49 offen offset:0 sc1
    ds_read_b128 v[48:51], v3 offset:38912
    s_waitcnt lgkmcnt(5)
    v_mfma_f32_16x16x32_bf16 v[60:63], v[28:31], v[120:123], v[60:63]
    ds_read_b128 v[52:55], v3 offset:39936
    s_waitcnt lgkmcnt(5)
    v_mfma_f32_16x16x32_bf16 v[64:67], v[32:35], v[120:123], v[64:67]
    ds_read_b128 v[24:27], v3 offset:40960
    s_waitcnt lgkmcnt(5)
    v_mfma_f32_16x16x32_bf16 v[68:71], v[36:39], v[120:123], v[68:71]
    ds_read_b128 v[28:31], v3 offset:41984
    s_waitcnt vmcnt(7)
    s_waitcnt lgkmcnt(5)
    v_mfma_f32_16x16x32_bf16 v[56:59], v[40:43], v[124:127], v[56:59]
    buffer_load_dwordx4 v[156:159], v1, s[40:43], s49 offen offset:1024 sc1
    ds_read_b128 v[32:35], v3 offset:43008
    s_waitcnt lgkmcnt(5)
    v_mfma_f32_16x16x32_bf16 v[60:63], v[44:47], v[124:127], v[60:63]
    ds_read_b128 v[36:39], v3 offset:44032
    s_waitcnt lgkmcnt(5)
    v_mfma_f32_16x16x32_bf16 v[64:67], v[48:51], v[124:127], v[64:67]
    ds_read_b128 v[40:43], v3 offset:45056
    s_waitcnt lgkmcnt(5)
    v_mfma_f32_16x16x32_bf16 v[68:71], v[52:55], v[124:127], v[68:71]
    ds_read_b128 v[44:47], v3 offset:46080
    s_waitcnt vmcnt(7)
    s_waitcnt lgkmcnt(5)
    v_mfma_f32_16x16x32_bf16 v[56:59], v[24:27], v[128:131], v[56:59]
    buffer_load_dwordx4 v[160:163], v1, s[40:43], s49 offen offset:2048 sc1
    ds_read_b128 v[48:51], v3 offset:47104
    s_waitcnt lgkmcnt(5)
    v_mfma_f32_16x16x32_bf16 v[60:63], v[28:31], v[128:131], v[60:63]
    ds_read_b128 v[52:55], v3 offset:48128
    s_waitcnt lgkmcnt(5)
    v_mfma_f32_16x16x32_bf16 v[64:67], v[32:35], v[128:131], v[64:67]
    ds_read_b128 v[24:27], v3 offset:49152
    s_waitcnt lgkmcnt(5)
    v_mfma_f32_16x16x32_bf16 v[68:71], v[36:39], v[128:131], v[68:71]
    ds_read_b128 v[28:31], v3 offset:50176
    s_waitcnt vmcnt(7)
    s_waitcnt lgkmcnt(5)
    v_mfma_f32_16x16x32_bf16 v[56:59], v[40:43], v[132:135], v[56:59]
    buffer_load_dwordx4 v[164:167], v1, s[40:43], s49 offen offset:3072 sc1
    ds_read_b128 v[32:35], v3 offset:51200
    s_waitcnt lgkmcnt(5)
    v_mfma_f32_16x16x32_bf16 v[60:63], v[44:47], v[132:135], v[60:63]
    ds_read_b128 v[36:39], v3 offset:52224
    s_waitcnt lgkmcnt(5)
    v_mfma_f32_16x16x32_bf16 v[64:67], v[48:51], v[132:135], v[64:67]
    ds_read_b128 v[40:43], v3 offset:53248
    s_waitcnt lgkmcnt(5)
    v_mfma_f32_16x16x32_bf16 v[68:71], v[52:55], v[132:135], v[68:71]
    ds_read_b128 v[44:47], v3 offset:54272
    s_waitcnt vmcnt(7)
    s_waitcnt lgkmcnt(5)
    v_mfma_f32_16x16x32_bf16 v[56:59], v[24:27], v[136:139], v[56:59]
    s_add_u32 s49, s49, 4096
    buffer_load_dwordx4 v[168:171], v1, s[40:43], s49 offen offset:0 sc1
    ds_read_b128 v[48:51], v3 offset:55296
    s_waitcnt lgkmcnt(5)
    v_mfma_f32_16x16x32_bf16 v[60:63], v[28:31], v[136:139], v[60:63]
    ds_read_b128 v[52:55], v3 offset:56320
    s_waitcnt lgkmcnt(5)
    v_mfma_f32_16x16x32_bf16 v[64:67], v[32:35], v[136:139], v[64:67]
    ds_read_b128 v[24:27], v3 offset:57344
    s_waitcnt lgkmcnt(5)
    v_mfma_f32_16x16x32_bf16 v[68:71], v[36:39], v[136:139], v[68:71]
    ds_read_b128 v[28:31], v3 offset:58368
    s_waitcnt vmcnt(7)
    s_waitcnt lgkmcnt(5)
    v_mfma_f32_16x16x32_bf16 v[56:59], v[40:43], v[140:143], v[56:59]
    buffer_load_dwordx4 v[172:175], v1, s[40:43], s49 offen offset:1024 sc1
    ds_read_b128 v[32:35], v3 offset:59392
    s_waitcnt lgkmcnt(5)
    v_mfma_f32_16x16x32_bf16 v[60:63], v[44:47], v[140:143], v[60:63]
    ds_read_b128 v[36:39], v3 offset:60416
    s_waitcnt lgkmcnt(5)
    v_mfma_f32_16x16x32_bf16 v[64:67], v[48:51], v[140:143], v[64:67]
    ds_read_b128 v[40:43], v3 offset:61440
    s_waitcnt lgkmcnt(5)
    v_mfma_f32_16x16x32_bf16 v[68:71], v[52:55], v[140:143], v[68:71]
    ds_read_b128 v[44:47], v3 offset:62464
    s_waitcnt vmcnt(7)
    s_waitcnt lgkmcnt(5)
    v_mfma_f32_16x16x32_bf16 v[56:59], v[24:27], v[144:147], v[56:59]
    buffer_load_dwordx4 v[176:179], v1, s[40:43], s49 offen offset:2048 sc1
    ds_read_b128 v[48:51], v3 offset:63488
    s_waitcnt lgkmcnt(5)
    v_mfma_f32_16x16x32_bf16 v[60:63], v[28:31], v[144:147], v[60:63]
    ds_read_b128 v[52:55], v3 offset:64512
    s_waitcnt lgkmcnt(5)
    v_mfma_f32_16x16x32_bf16 v[64:67], v[32:35], v[144:147], v[64:67]
    ds_read_b128 v[24:27], v4 offset:0
    s_waitcnt lgkmcnt(5)
    v_mfma_f32_16x16x32_bf16 v[68:71], v[36:39], v[144:147], v[68:71]
    ds_read_b128 v[28:31], v4 offset:1024
    s_waitcnt vmcnt(7)
    s_waitcnt lgkmcnt(5)
    v_mfma_f32_16x16x32_bf16 v[56:59], v[40:43], v[148:151], v[56:59]
    s_add_u32 s49, s49, 4096
    buffer_load_dwordx4 v[180:183], v1, s[40:43], s49 offen offset:1024 sc1
    ds_read_b128 v[32:35], v4 offset:2048
    s_waitcnt lgkmcnt(5)
    v_mfma_f32_16x16x32_bf16 v[60:63], v[44:47], v[148:151], v[60:63]
    ds_read_b128 v[36:39], v4 offset:3072
    s_waitcnt lgkmcnt(5)
    v_mfma_f32_16x16x32_bf16 v[64:67], v[48:51], v[148:151], v[64:67]
    ds_read_b128 v[40:43], v4 offset:4096
    s_waitcnt lgkmcnt(5)
    v_mfma_f32_16x16x32_bf16 v[68:71], v[52:55], v[148:151], v[68:71]
    ds_read_b128 v[44:47], v4 offset:5120
    s_waitcnt vmcnt(7)
    s_waitcnt lgkmcnt(5)
    v_mfma_f32_16x16x32_bf16 v[56:59], v[24:27], v[152:155], v[56:59]
    buffer_load_dwordx4 v[184:187], v1, s[40:43], s49 offen offset:2048 sc1
    ds_read_b128 v[48:51], v4 offset:6144
    s_waitcnt lgkmcnt(5)
    v_mfma_f32_16x16x32_bf16 v[60:63], v[28:31], v[152:155], v[60:63]
    ds_read_b128 v[52:55], v4 offset:7168
    s_waitcnt lgkmcnt(5)
    v_mfma_f32_16x16x32_bf16 v[64:67], v[32:35], v[152:155], v[64:67]
    ds_read_b128 v[24:27], v4 offset:8192
    s_waitcnt lgkmcnt(5)
    v_mfma_f32_16x16x32_bf16 v[68:71], v[36:39], v[152:155], v[68:71]
    ds_read_b128 v[28:31], v4 offset:9216
    s_waitcnt vmcnt(7)
    s_waitcnt lgkmcnt(5)
    v_mfma_f32_16x16x32_bf16 v[56:59], v[40:43], v[156:159], v[56:59]
    ds_read_b128 v[32:35], v4 offset:10240
    s_waitcnt lgkmcnt(5)
    v_mfma_f32_16x16x32_bf16 v[60:63], v[44:47], v[156:159], v[60:63]
    ds_read_b128 v[36:39], v4 offset:11264
    s_waitcnt lgkmcnt(5)
    v_mfma_f32_16x16x32_bf16 v[64:67], v[48:51], v[156:159], v[64:67]
    ds_read_b128 v[40:43], v4 offset:12288
    s_waitcnt lgkmcnt(5)
    v_mfma_f32_16x16x32_bf16 v[68:71], v[52:55], v[156:159], v[68:71]
    ds_read_b128 v[44:47], v4 offset:13312
    s_waitcnt vmcnt(6)
    s_waitcnt lgkmcnt(5)
    v_mfma_f32_16x16x32_bf16 v[56:59], v[24:27], v[160:163], v[56:59]
    ds_read_b128 v[48:51], v4 offset:14336
    s_waitcnt lgkmcnt(5)
    v_mfma_f32_16x16x32_bf16 v[60:63], v[28:31], v[160:163], v[60:63]
    ds_read_b128 v[52:55], v4 offset:15360
    s_waitcnt lgkmcnt(5)
    v_mfma_f32_16x16x32_bf16 v[64:67], v[32:35], v[160:163], v[64:67]
    ds_read_b128 v[24:27], v4 offset:16384
    s_waitcnt lgkmcnt(5)
    v_mfma_f32_16x16x32_bf16 v[68:71], v[36:39], v[160:163], v[68:71]
    ds_read_b128 v[28:31], v4 offset:17408
    s_waitcnt vmcnt(5)
    s_waitcnt lgkmcnt(5)
    v_mfma_f32_16x16x32_bf16 v[56:59], v[40:43], v[164:167], v[56:59]
    ds_read_b128 v[32:35], v4 offset:18432
    s_waitcnt lgkmcnt(5)
    v_mfma_f32_16x16x32_bf16 v[60:63], v[44:47], v[164:167], v[60:63]
    ds_read_b128 v[36:39], v4 offset:19456
    s_waitcnt lgkmcnt(5)
    v_mfma_f32_16x16x32_bf16 v[64:67], v[48:51], v[164:167], v[64:67]
    ds_read_b128 v[40:43], v4 offset:20480
    s_waitcnt lgkmcnt(5)
    v_mfma_f32_16x16x32_bf16 v[68:71], v[52:55], v[164:167], v[68:71]
    ds_read_b128 v[44:47], v4 offset:21504
    s_waitcnt vmcnt(4)
    s_waitcnt lgkmcnt(5)
    v_mfma_f32_16x16x32_bf16 v[56:59], v[24:27], v[168:171], v[56:59]
    ds_read_b128 v[48:51], v4 offset:22528
    s_waitcnt lgkmcnt(5)
    v_mfma_f32_16x16x32_bf16 v[60:63], v[28:31], v[168:171], v[60:63]
    ds_read_b128 v[52:55], v4 offset:23552
    s_waitcnt lgkmcnt(5)
    v_mfma_f32_16x16x32_bf16 v[64:67], v[32:35], v[168:171], v[64:67]
    ds_read_b128 v[24:27], v4 offset:24576
    s_waitcnt lgkmcnt(5)
    v_mfma_f32_16x16x32_bf16 v[68:71], v[36:39], v[168:171], v[68:71]
    ds_read_b128 v[28:31], v4 offset:25600
    s_waitcnt vmcnt(3)
    s_waitcnt lgkmcnt(5)
    v_mfma_f32_16x16x32_bf16 v[56:59], v[40:43], v[172:175], v[56:59]
    ds_read_b128 v[32:35], v4 offset:26624
    s_waitcnt lgkmcnt(5)
    v_mfma_f32_16x16x32_bf16 v[60:63], v[44:47], v[172:175], v[60:63]
    ds_read_b128 v[36:39], v4 offset:27648
    s_waitcnt lgkmcnt(5)
    v_mfma_f32_16x16x32_bf16 v[64:67], v[48:51], v[172:175], v[64:67]
    s_waitcnt lgkmcnt(4)
    v_mfma_f32_16x16x32_bf16 v[68:71], v[52:55], v[172:175], v[68:71]
    s_waitcnt vmcnt(2)
    s_waitcnt lgkmcnt(3)
    v_mfma_f32_16x16x32_bf16 v[56:59], v[24:27], v[176:179], v[56:59]
    s_waitcnt lgkmcnt(2)
    v_mfma_f32_16x16x32_bf16 v[60:63], v[28:31], v[176:179], v[60:63]
    s_waitcnt lgkmcnt(1)
    v_mfma_f32_16x16x32_bf16 v[64:67], v[32:35], v[176:179], v[64:67]
    s_waitcnt lgkmcnt(0)
    v_mfma_f32_16x16x32_bf16 v[68:71], v[36:39], v[176:179], v[68:71]
    s_setprio 0
    s_setprio 2
    s_waitcnt vmcnt(1)
    v_mfma_f32_16x16x32_bf16 v[56:59], v[192:195], v[180:183], v[56:59]
    v_mfma_f32_16x16x32_bf16 v[60:63], v[196:199], v[180:183], v[60:63]
    v_mfma_f32_16x16x32_bf16 v[64:67], v[200:203], v[180:183], v[64:67]
    v_mfma_f32_16x16x32_bf16 v[68:71], v[204:207], v[180:183], v[68:71]
    s_waitcnt vmcnt(0)
    v_mfma_f32_16x16x32_bf16 v[56:59], v[208:211], v[184:187], v[56:59]
    v_mfma_f32_16x16x32_bf16 v[60:63], v[212:215], v[184:187], v[60:63]
    v_mfma_f32_16x16x32_bf16 v[64:67], v[216:219], v[184:187], v[64:67]
    v_mfma_f32_16x16x32_bf16 v[68:71], v[220:223], v[184:187], v[68:71]
    s_setprio 0
L_p4done:
    s_nop 7
    s_barrier
    s_lshl_b32 s47, s46, 11
    s_add_u32 s47, s47, 8192
    v_add_u32 v86, s47, v1
    s_xor_b32 s48, s46, 4
    s_lshl_b32 s48, s48, 11
    s_add_u32 s48, s48, 8192
    v_add_u32 v87, s48, v1
    s_nop 4
    s_cmp_eq_u32 s54, 0
    s_cbranch_scc0 L_ex0_25
    ds_write_b128 v86, v[64:67]
    ds_write_b128 v86, v[68:71] offset:1024
    v_mov_b32 v72, v56
    v_mov_b32 v73, v57
    v_mov_b32 v74, v58
    v_mov_b32 v75, v59
    v_mov_b32 v76, v60
    v_mov_b32 v77, v61
    v_mov_b32 v78, v62
    v_mov_b32 v79, v63
    s_branch L_ex1_26
L_ex0_25:
    ds_write_b128 v86, v[56:59]
    ds_write_b128 v86, v[60:63] offset:1024
    v_mov_b32 v72, v64
    v_mov_b32 v73, v65
    v_mov_b32 v74, v66
    v_mov_b32 v75, v67
    v_mov_b32 v76, v68
    v_mov_b32 v77, v69
    v_mov_b32 v78, v70
    v_mov_b32 v79, v71
L_ex1_26:
    s_waitcnt lgkmcnt(0)
    s_barrier
    ds_read_b128 v[56:59], v87
    ds_read_b128 v[60:63], v87 offset:1024
    s_waitcnt lgkmcnt(0)
    v_add_f32 v72, v72, v56
    v_add_f32 v73, v73, v57
    v_add_f32 v74, v74, v58
    v_add_f32 v75, v75, v59
    v_add_f32 v76, v76, v60
    v_add_f32 v77, v77, v61
    v_add_f32 v78, v78, v62
    v_add_f32 v79, v79, v63
    v_lshlrev_b32 v88, 16, v20
    v_and_b32 v89, 0xffff0000, v20
    v_add_f32 v88, v88, v72
    v_add_f32 v89, v89, v73
    v_cvt_pk_bf16_f32 v92, v88, v89
    v_lshlrev_b32 v90, 16, v21
    v_and_b32 v91, 0xffff0000, v21
    v_add_f32 v90, v90, v74
    v_add_f32 v91, v91, v75
    v_cvt_pk_bf16_f32 v93, v90, v91
    v_lshlrev_b32 v88, 16, v22
    v_and_b32 v89, 0xffff0000, v22
    v_add_f32 v88, v88, v76
    v_add_f32 v89, v89, v77
    v_cvt_pk_bf16_f32 v94, v88, v89
    v_lshlrev_b32 v90, 16, v23
    v_and_b32 v91, 0xffff0000, v23
    v_add_f32 v90, v90, v78
    v_add_f32 v91, v91, v79
    v_cvt_pk_bf16_f32 v95, v90, v91
    v_lshlrev_b32 v86, 10, v81
    v_lshl_add_u32 v86, v82, 4, v86
    s_lshl_b32 s48, s53, 14
    s_add_u32 s48, s48, s52
    s_lshl_b32 s49, s54, 6
    s_add_u32 s48, s48, s49
    buffer_store_dwordx4 v[92:95], v86, s[32:35], s48 offen
L_end:
    s_endpgm
.section .rodata,"a"
.p2align 6
.amdhsa_kernel sequential_preLN__linear_attn_block__dense_activation_mish__prompt_kernel
  .amdhsa_next_free_vgpr 256
  .amdhsa_next_free_sgpr 102
  .amdhsa_accum_offset 256
  .amdhsa_group_segment_fixed_size 0
  .amdhsa_kernarg_size 80
  .amdhsa_user_sgpr_count 2
  .amdhsa_user_sgpr_kernarg_segment_ptr 1
  .amdhsa_system_sgpr_workgroup_id_x 1
.end_amdhsa_kernel
```
